```python
import torch

def _softmax(x, axis=-1):
    return torch.softmax(x, dim=axis)
def _gelu(x):
    return torch.nn.functional.gelu(x, approximate="tanh")
def _silu(x):
    return torch.nn.functional.silu(x)
def _sigmoid(x):
    return torch.sigmoid(x)
def _layernorm(x, axis=-1, eps=1e-5):
    m = x.mean(dim=axis, keepdim=True)
    v = x.var(dim=axis, keepdim=True, unbiased=False)
    return (x - m) / torch.sqrt(v + eps)
def _scatter_add(tgt, idx, src, axis=0):
    return tgt.clone().index_add_(axis, idx, src)
def _segment_sum(src, seg, n):
    out = torch.zeros((n,) + src.shape[1:], dtype=src.dtype)
    return out.index_add_(0, seg, src)
def _pad(x, pw):
    flat = tuple(v for pair in reversed(pw) for v in pair)
    return torch.nn.functional.pad(x, flat)

kernel_name = 'recurrent_scan__ssm_conv_h3__geglu_ffn__prompt'

def setup_inputs():

    _w = (lambda a: (lambda t: t.to(torch.bfloat16) if t.is_floating_point() else t)(torch.as_tensor(a)))
    def _A_setup():
        B, S, D = 1, 2048, 448
        ks = 4
        return {
            "q": _w((lambda *s: torch.randn(*s, dtype=torch.bfloat16) * 0.05)(B, S, D)),
            "k": _w((lambda *s: torch.randn(*s, dtype=torch.bfloat16) * 0.2)(B, S, D)),
            "v": _w((lambda *s: torch.randn(*s, dtype=torch.bfloat16) * 0.2)(B, S, D)),
            "shift_k": _w((lambda *s: torch.randn(*s, dtype=torch.bfloat16) * 0.2)(D, ks) * 0.5),
            "ssm_k": _w((lambda *s: torch.randn(*s, dtype=torch.bfloat16) * 0.2)(D, S) * (1.0 / S ** 0.5)),
            "ssm_D": _w((lambda *s: torch.randn(*s, dtype=torch.bfloat16) * 0.2)(D)),
        }
    _A_in = _A_setup()

    def _B_setup():
        B, S, D, F = 1, 2048, 448, 1792
        return {
            "x": _w((lambda *s: torch.randn(*s, dtype=torch.bfloat16) * 0.05)(B, S, D)),
            "w_gate": _w((lambda *s: torch.randn(*s, dtype=torch.bfloat16) * 0.1)(D, F)),
            "w_up": _w((lambda *s: torch.randn(*s, dtype=torch.bfloat16) * 0.1)(D, F)),
            "w_down": _w((lambda *s: torch.randn(*s, dtype=torch.bfloat16) * 0.1)(F, D)),
        }
    _B_in = _B_setup()

    return {
        "A_q": _A_in["q"],
        "A_k": _A_in["k"],
        "A_v": _A_in["v"],
        "A_shift_k": _A_in["shift_k"],
        "A_ssm_k": _A_in["ssm_k"],
        "A_ssm_D": _A_in["ssm_D"],
        "B_x": _B_in["x"],
        "B_w_gate": _B_in["w_gate"],
        "B_w_up": _B_in["w_up"],
        "B_w_down": _B_in["w_down"],
    }

def reference(A_q, A_k, A_v, A_shift_k, A_ssm_k, A_ssm_D, B_x, B_w_gate, B_w_up, B_w_down):
    def _A_ref(q, k, v, shift_k, ssm_k, ssm_D):
        B, S, D = q.shape
        ks = shift_k.shape[-1]
        k_pad = _pad(k, ((0, 0), (ks - 1, 0), (0, 0)))
        k_shift = torch.zeros_like(k)
        for t in range(ks):
            k_shift = k_shift + k_pad[:, t:t + S, :] * shift_k[:, ks - 1 - t][None, None, :]
        kv = k_shift * v
        L = 2 * S
        kv_pad = _pad(kv, ((0, 0), (0, S), (0, 0)))
        kf_pad = _pad(ssm_k, ((0, 0), (0, S)))
        kv_f = (lambda x, axes=(-2,-1): torch.fft.rfft2(x.float(), dim=axes))(kv_pad[:, None, :, :], axes=(1, 2))
        kf_f = (lambda x, axes=(-2,-1): torch.fft.rfft2(x.float(), dim=axes))(kf_pad[:, None, :], axes=(1, 2))
        kf_f = (lambda x, *d: x.permute(*d))(kf_f, 1, 2, 0)
        y_f = kv_f * kf_f[None, :, :, :]
        y = (lambda x, s, axes=(-2,-1): torch.fft.irfft2(x, s=s, dim=axes).to(torch.bfloat16))(y_f, (1, L), axes=(1, 2))[:, 0, :S, :]
        y = y + kv * ssm_D[None, None, :]
        return q * y

    def _B_ref(x, w_gate, w_up, w_down):
        return (_gelu(x @ w_gate) * (x @ w_up)) @ w_down

    x = A_q
    xn = _layernorm(x, axis=-1)
    s = _A_ref(xn, A_k, A_v, A_shift_k, A_ssm_k, A_ssm_D)
    g = _silu(_B_ref(xn, B_w_gate, B_w_up, B_w_down))
    return x + s * g
```

```asm
; @launch grid=(256,1,1) block=(256,1,1) lds=163840
.amdgcn_target "amdgcn-amd-amdhsa--gfx950"
.text
.globl recurrent_scan__ssm_conv_h3__geglu_ffn__prompt_kernel
.p2align 8
.type recurrent_scan__ssm_conv_h3__geglu_ffn__prompt_kernel,@function
recurrent_scan__ssm_conv_h3__geglu_ffn__prompt_kernel:
s_cmp_ge_u32 s2, 224
s_cbranch_scc1 L_spare
s_load_dwordx2 s[4:5], s[0:1], 0
s_load_dwordx2 s[8:9], s[0:1], 56
s_load_dwordx2 s[12:13], s[0:1], 64
s_load_dwordx2 s[20:21], s[0:1], 8
s_load_dwordx2 s[24:25], s[0:1], 16
s_load_dwordx2 s[28:29], s[0:1], 24
s_load_dwordx2 s[16:17], s[0:1], 96
s_load_dwordx2 s[56:57], s[0:1], 72
s_load_dwordx2 s[60:61], s[0:1], 32
s_load_dwordx2 s[64:65], s[0:1], 80
s_load_dwordx2 s[96:97], s[0:1], 40
    v_and_b32 v1, 63, v0
    v_lshrrev_b32 v20, 6, v0
    s_lshr_b32 s45, s2, 3
    s_and_b32 s46, s2, 7
    v_readfirstlane_b32 s36, v20
    s_mul_i32 s47, s45, 37
    s_lshr_b32 s47, s47, 8
    s_mul_i32 s48, s47, 7
    s_sub_u32 s53, s45, s48
    s_lshr_b32 s37, s46, 1
    s_lshl_b32 s37, s37, 2
    s_add_u32 s37, s37, s47
    s_and_b32 s52, s46, 1
    s_mul_i32 s46, s52, 7
    s_add_u32 s38, s53, s46
    v_lshrrev_b32 v20, 3, v1
    v_lshrrev_b32 v21, 4, v1
    v_and_b32 v22, 7, v1
    v_mul_u32_u24 v20, 896, v20
    v_xor_b32 v23, v22, v21
    v_xor_b32 v28, 4, v23
    v_lshl_add_u32 v2, v23, 4, v20
    v_lshl_add_u32 v28, v28, 4, v20
    v_add_u32 v3, 6144, v28
    v_add_u32 v4, 12288, v2
    v_add_u32 v5, 18432, v28
    v_and_b32 v22, 15, v1
    v_lshlrev_b32 v23, 2, v21
    v_sub_u32 v22, v22, v23
    v_and_b32 v22, 15, v22
    v_mul_u32_u24 v23, 3584, v21
    v_lshl_add_u32 v6, v22, 4, v23
    v_add_u32 v7, 13312, v6
    v_add_u32 v8, 26624, v6
    v_add_u32 v9, 39936, v6
    s_lshl_b32 s45, s37, 7
    s_lshl_b32 s46, s36, 5
    s_add_u32 s45, s45, s46
    s_mul_i32 s41, s45, 896
    s_mul_i32 s42, s36, 57344
    s_lshl_b32 s45, s38, 8
    s_add_u32 s42, s42, s45
    s_lshl_b32 s43, s36, 12
    s_add_u32 s44, s43, 49152
    s_and_b32 s39, s36, 1
    s_lshr_b32 s40, s36, 1
    s_lshl_b32 s3, s36, 11
    v_lshlrev_b32 v18, 4, v1
    s_waitcnt lgkmcnt(0)

s_and_b32 s5, s5, 0xffff
s_mov_b32 s6, 1835008
s_mov_b32 s7, 0x20000
s_and_b32 s9, s9, 0xffff
s_mov_b32 s10, 1605632
s_mov_b32 s11, 0x20000
s_and_b32 s13, s13, 0xffff
s_mov_b32 s14, 1605632
s_mov_b32 s15, 0x20000
s_add_u32 m0, s43, 0
s_add_u32 s48, s41, 0
buffer_load_dwordx4 v2, s[4:7], s48 offen offset:0 lds
buffer_load_dwordx4 v3, s[4:7], s48 offen offset:1024 lds
buffer_load_dwordx4 v4, s[4:7], s48 offen offset:2048 lds
buffer_load_dwordx4 v5, s[4:7], s48 offen offset:3072 lds
s_add_u32 m0, s44, 0
s_add_u32 s48, s42, 0
buffer_load_dwordx4 v6, s[8:11], s48 offen offset:0 lds
buffer_load_dwordx4 v7, s[8:11], s48 offen offset:1024 lds
buffer_load_dwordx4 v8, s[8:11], s48 offen offset:2048 lds
buffer_load_dwordx4 v9, s[8:11], s48 offen offset:3072 lds
s_add_u32 m0, s44, 16384
s_add_u32 s48, s42, 0
buffer_load_dwordx4 v6, s[12:15], s48 offen offset:0 lds
buffer_load_dwordx4 v7, s[12:15], s48 offen offset:1024 lds
buffer_load_dwordx4 v8, s[12:15], s48 offen offset:2048 lds
buffer_load_dwordx4 v9, s[12:15], s48 offen offset:3072 lds
s_mov_b32 s51, 0
s_load_dword s50, s[16:17], s51
s_lshl_b32 s98, s2, 2
s_load_dword s99, s[96:97], s98
v_and_b32 v20, 31, v1
v_lshrrev_b32 v21, 5, v1
v_bfe_u32 v22, v1, 1, 3
v_xor_b32 v22, v22, v21
s_lshl_b32 s45, s40, 13
v_lshl_add_u32 v20, v20, 7, s45
v_xor_b32 v23, 0, v22
v_lshl_add_u32 v10, v23, 4, v20
v_xor_b32 v23, 2, v22
v_lshl_add_u32 v11, v23, 4, v20
v_xor_b32 v23, 4, v22
v_lshl_add_u32 v12, v23, 4, v20
v_xor_b32 v23, 6, v22
v_lshl_add_u32 v13, v23, 4, v20
v_bfe_u32 v20, v1, 2, 2
v_bfe_u32 v22, v1, 4, 1
v_bfe_u32 v23, v1, 1, 1
v_and_b32 v24, 1, v1
v_lshl_add_u32 v22, v22, 1, v23
v_lshlrev_b32 v25, 11, v21
v_lshl_add_u32 v25, v20, 8, v25
v_lshl_add_u32 v25, v24, 3, v25
v_lshl_add_u32 v25, v22, 4, v25
v_add_u32 v25, 49152, v25
s_lshl_b32 s45, s39, 1
v_add_u32 v26, s45, v20
v_add_u32 v26, 0, v26
v_and_b32 v26, 3, v26
v_lshl_add_u32 v14, v26, 6, v25
v_add_u32 v16, 65536, v14
v_add_u32 v26, s45, v20
v_add_u32 v26, 1, v26
v_and_b32 v26, 3, v26
v_lshl_add_u32 v15, v26, 6, v25
v_add_u32 v17, 65536, v15
s_add_u32 m0, s43, 16384
s_add_u32 s48, s41, 128
buffer_load_dwordx4 v2, s[4:7], s48 offen offset:0 lds
buffer_load_dwordx4 v3, s[4:7], s48 offen offset:1024 lds
buffer_load_dwordx4 v4, s[4:7], s48 offen offset:2048 lds
buffer_load_dwordx4 v5, s[4:7], s48 offen offset:3072 lds
s_add_u32 m0, s44, 32768
s_add_u32 s48, s42, 229376
buffer_load_dwordx4 v6, s[8:11], s48 offen offset:0 lds
buffer_load_dwordx4 v7, s[8:11], s48 offen offset:1024 lds
buffer_load_dwordx4 v8, s[8:11], s48 offen offset:2048 lds
buffer_load_dwordx4 v9, s[8:11], s48 offen offset:3072 lds
s_add_u32 m0, s44, 49152
s_add_u32 s48, s42, 229376
buffer_load_dwordx4 v6, s[12:15], s48 offen offset:0 lds
buffer_load_dwordx4 v7, s[12:15], s48 offen offset:1024 lds
buffer_load_dwordx4 v8, s[12:15], s48 offen offset:2048 lds
buffer_load_dwordx4 v9, s[12:15], s48 offen offset:3072 lds
s_and_b32 s21, s21, 0xffff
s_mov_b32 s22, 1835008
s_mov_b32 s23, 0x20000
s_and_b32 s25, s25, 0xffff
s_mov_b32 s26, 1835008
s_mov_b32 s27, 0x20000
s_and_b32 s29, s29, 0xffff
s_mov_b32 s30, 3584
s_mov_b32 s31, 0x20000
s_and_b32 s17, s17, 0xffff
s_mov_b32 s18, 11337728
s_mov_b32 s19, 0x20000
s_and_b32 s57, s57, 0xffff
s_mov_b32 s58, 1605632
s_mov_b32 s59, 0x20000
s_and_b32 s61, s61, 0xffff
s_mov_b32 s62, 1835008
s_mov_b32 s63, 0x20000
v_and_b32 v90, 15, v1
s_lshl_b32 s45, s38, 5
s_lshl_b32 s46, s39, 4
s_add_u32 s45, s45, s46
s_lshl_b32 s46, s45, 3
v_lshlrev_b32 v91, 3, v90
buffer_load_dwordx2 v[88:89], v91, s[28:31], s46 offen
v_lshrrev_b32 v106, 2, v1
v_and_b32 v107, 3, v1
v_mul_u32_u24 v106, 896, v106
v_lshl_add_u32 v104, v107, 4, v106
v_add_u32 v105, 13312, v104
s_lshl_b32 s45, s37, 7
s_lshl_b32 s46, s36, 5
s_add_u32 s45, s45, s46
s_mul_i32 s34, s45, 896
s_lshl_b32 s47, s38, 6
s_add_u32 s34, s34, s47
v_and_b32 v106, 15, v1
v_lshrrev_b32 v107, 2, v106
v_and_b32 v106, 3, v106
v_lshl_add_u32 v106, v107, 4, v106
v_lshrrev_b32 v107, 5, v1
v_sub_u32 v106, v106, v107
v_add_u32 v106, 1, v106
v_mul_u32_u24 v106, 896, v106
v_bfe_u32 v107, v1, 4, 1
v_lshl_add_u32 v106, v107, 4, v106
s_lshl_b32 s45, s37, 7
s_lshl_b32 s46, s40, 6
s_add_u32 s45, s45, s46
s_mul_i32 s35, s45, 896
s_add_u32 s35, s35, s47
s_lshl_b32 s46, s39, 5
s_add_u32 s35, s35, s46
s_cmp_eq_u32 s45, 0
s_cselect_b32 s46, 0, 2688
s_cselect_b32 s47, 2688, 0
s_sub_u32 s35, s35, s46
v_subrev_u32 v106, s47, v106
v_add_u32 v107, 1792, v106
s_waitcnt lgkmcnt(0)
s_mul_i32 s50, s50, 0x9E3779B1
s_add_u32 s50, s50, 0x7F4A7C15
s_lshl_b32 s100, s99, 16
s_and_b32 s101, s99, 0xffff0000
s_waitcnt vmcnt(13)
s_barrier
ds_read_b128 v[20:23], v10 offset:0
ds_read_b128 v[24:27], v10 offset:4096
ds_read_b64_tr_b16 v[28:29], v14 offset:0
ds_read_b64_tr_b16 v[30:31], v14 offset:1024
ds_read_b64_tr_b16 v[32:33], v15 offset:0
ds_read_b64_tr_b16 v[34:35], v15 offset:1024
ds_read_b64_tr_b16 v[36:37], v14 offset:16384
ds_read_b64_tr_b16 v[38:39], v14 offset:17408
ds_read_b64_tr_b16 v[40:41], v15 offset:16384
ds_read_b64_tr_b16 v[42:43], v15 offset:17408
s_waitcnt lgkmcnt(0)
v_mfma_f32_32x32x16_bf16 v[128:143], v[28:31], v[20:23], 0
ds_read_b128 v[44:47], v11 offset:0
ds_read_b128 v[48:51], v11 offset:4096
v_and_b32 v108, 15, v1
v_lshrrev_b32 v109, 4, v1
v_lshrrev_b32 v110, 2, v108
v_mfma_f32_32x32x16_bf16 v[192:207], v[36:39], v[20:23], 0
ds_read_b64_tr_b16 v[52:53], v14 offset:4096
ds_read_b64_tr_b16 v[54:55], v14 offset:5120
v_and_b32 v111, 3, v108
v_lshl_add_u32 v110, v110, 4, v111
v_lshrrev_b32 v111, 1, v109
s_add_u32 m0, s43, 32768
s_add_u32 s48, s41, 256
buffer_load_dwordx4 v2, s[4:7], s48 offen offset:0 lds
v_mfma_f32_32x32x16_bf16 v[144:159], v[28:31], v[24:27], 0
ds_read_b64_tr_b16 v[56:57], v15 offset:4096
ds_read_b64_tr_b16 v[58:59], v15 offset:5120
v_sub_u32 v110, v110, v111
v_add_u32 v110, 2, v110
s_lshl_b32 s45, s40, 6
v_mfma_f32_32x32x16_bf16 v[208:223], v[36:39], v[24:27], 0
ds_read_b64_tr_b16 v[60:61], v14 offset:20480
ds_read_b64_tr_b16 v[62:63], v14 offset:21504
v_add_u32 v110, s45, v110
v_lshlrev_b32 v110, 6, v110
v_and_b32 v111, 1, v109
buffer_load_dwordx4 v3, s[4:7], s48 offen offset:1024 lds
v_mfma_f32_32x32x16_bf16 v[160:175], v[32:35], v[20:23], 0
ds_read_b64_tr_b16 v[64:65], v15 offset:20480
ds_read_b64_tr_b16 v[66:67], v15 offset:21504
v_lshl_add_u32 v110, v111, 4, v110
s_lshl_b32 s46, s39, 5
s_add_u32 s47, s46, 147456
v_mfma_f32_32x32x16_bf16 v[224:239], v[40:43], v[20:23], 0
v_add_u32 v80, s47, v110
v_lshrrev_b32 v110, 2, v108
v_lshl_add_u32 v110, v109, 4, v110
buffer_load_dwordx4 v4, s[4:7], s48 offen offset:2048 lds
v_mfma_f32_32x32x16_bf16 v[176:191], v[32:35], v[24:27], 0
v_add_u32 v110, s45, v110
v_lshlrev_b32 v110, 6, v110
v_and_b32 v111, 3, v108
v_mfma_f32_32x32x16_bf16 v[240:255], v[40:43], v[24:27], 0
v_lshl_add_u32 v110, v111, 3, v110
s_add_u32 s47, s46, 155648
v_add_u32 v81, s47, v110
buffer_load_dwordx4 v5, s[4:7], s48 offen offset:3072 lds
s_waitcnt lgkmcnt(0)
v_mfma_f32_32x32x16_bf16 v[128:143], v[52:55], v[44:47], v[128:143]
ds_read_b128 v[20:23], v12 offset:0
ds_read_b128 v[24:27], v12 offset:4096
v_lshlrev_b32 v110, 1, v109
v_sub_u32 v110, 6, v110
v_and_b32 v111, 7, v108
v_mfma_f32_32x32x16_bf16 v[192:207], v[60:63], v[44:47], v[192:207]
ds_read_b64_tr_b16 v[28:29], v14 offset:8192
ds_read_b64_tr_b16 v[30:31], v14 offset:9216
v_xor_b32 v110, v110, v111
v_xor_b32 v111, 1, v110
v_lshlrev_b32 v83, 7, v108
s_add_u32 m0, s44, 65536
s_add_u32 s48, s42, 458752
buffer_load_dwordx4 v6, s[8:11], s48 offen offset:0 lds
v_mfma_f32_32x32x16_bf16 v[144:159], v[52:55], v[48:51], v[144:159]
ds_read_b64_tr_b16 v[32:33], v15 offset:8192
ds_read_b64_tr_b16 v[34:35], v15 offset:9216
s_add_u32 s46, s3, 147456
v_add_u32 v83, s46, v83
v_lshl_add_u32 v82, v110, 4, v83
v_mfma_f32_32x32x16_bf16 v[208:223], v[60:63], v[48:51], v[208:223]
ds_read_b64_tr_b16 v[36:37], v14 offset:24576
ds_read_b64_tr_b16 v[38:39], v14 offset:25600
v_lshl_add_u32 v83, v111, 4, v83
v_lshrrev_b32 v110, 3, v1
v_and_b32 v111, 7, v1
buffer_load_dwordx4 v7, s[8:11], s48 offen offset:1024 lds
v_mfma_f32_32x32x16_bf16 v[160:175], v[56:59], v[44:47], v[160:175]
ds_read_b64_tr_b16 v[40:41], v15 offset:24576
ds_read_b64_tr_b16 v[42:43], v15 offset:25600
v_xor_b32 v84, v111, v110
v_lshlrev_b32 v85, 7, v110
v_lshl_add_u32 v84, v84, 4, v85
v_mfma_f32_32x32x16_bf16 v[224:239], v[64:67], v[44:47], v[224:239]
v_add_u32 v84, s46, v84
v_lshlrev_b32 v85, 12, v110
v_lshl_add_u32 v85, v111, 4, v85
buffer_load_dwordx4 v8, s[8:11], s48 offen offset:2048 lds
v_mfma_f32_32x32x16_bf16 v[176:191], v[56:59], v[48:51], v[176:191]
s_lshl_b32 s45, s38, 5
s_lshl_b32 s46, s39, 4
s_add_u32 s45, s45, s46
v_mfma_f32_32x32x16_bf16 v[240:255], v[64:67], v[48:51], v[240:255]
s_lshl_b32 s45, s45, 12
s_lshl_b32 s46, s37, 8
s_lshl_b32 s47, s40, 7
buffer_load_dwordx4 v9, s[8:11], s48 offen offset:3072 lds
s_waitcnt lgkmcnt(0)
v_mfma_f32_32x32x16_bf16 v[128:143], v[28:31], v[20:23], v[128:143]
ds_read_b128 v[44:47], v13 offset:0
ds_read_b128 v[48:51], v13 offset:4096
s_add_u32 s46, s46, s47
v_mfma_f32_32x32x16_bf16 v[192:207], v[36:39], v[20:23], v[192:207]
ds_read_b64_tr_b16 v[52:53], v14 offset:12288
ds_read_b64_tr_b16 v[54:55], v14 offset:13312
s_add_u32 m0, s44, 81920
s_add_u32 s48, s42, 458752
buffer_load_dwordx4 v6, s[12:15], s48 offen offset:0 lds
v_mfma_f32_32x32x16_bf16 v[144:159], v[28:31], v[24:27], v[144:159]
ds_read_b64_tr_b16 v[56:57], v15 offset:12288
ds_read_b64_tr_b16 v[58:59], v15 offset:13312
s_sub_u32 s45, s45, s46
v_mfma_f32_32x32x16_bf16 v[208:223], v[36:39], v[24:27], v[208:223]
ds_read_b64_tr_b16 v[60:61], v14 offset:28672
ds_read_b64_tr_b16 v[62:63], v14 offset:29696
buffer_load_dwordx4 v7, s[12:15], s48 offen offset:1024 lds
v_mfma_f32_32x32x16_bf16 v[160:175], v[32:35], v[20:23], v[160:175]
ds_read_b64_tr_b16 v[64:65], v15 offset:28672
ds_read_b64_tr_b16 v[66:67], v15 offset:29696
s_add_u32 s94, s45, 331648
v_mfma_f32_32x32x16_bf16 v[224:239], v[40:43], v[20:23], v[224:239]
buffer_load_dwordx4 v8, s[12:15], s48 offen offset:2048 lds
v_mfma_f32_32x32x16_bf16 v[176:191], v[32:35], v[24:27], v[176:191]
s_add_u32 s95, s94, 32768
v_mfma_f32_32x32x16_bf16 v[240:255], v[40:43], v[24:27], v[240:255]
buffer_load_dwordx4 v9, s[12:15], s48 offen offset:3072 lds
s_waitcnt lgkmcnt(0)
s_waitcnt vmcnt(13)
s_barrier
v_mfma_f32_32x32x16_bf16 v[128:143], v[52:55], v[44:47], v[128:143]
ds_read_b128 v[20:23], v10 offset:16384
ds_read_b128 v[24:27], v10 offset:20480
v_mfma_f32_32x32x16_bf16 v[192:207], v[60:63], v[44:47], v[192:207]
ds_read_b64_tr_b16 v[28:29], v14 offset:32768
ds_read_b64_tr_b16 v[30:31], v14 offset:33792
s_add_u32 m0, s43, 0
s_add_u32 s48, s41, 384
buffer_load_dwordx4 v2, s[4:7], s48 offen offset:0 lds
v_mfma_f32_32x32x16_bf16 v[144:159], v[52:55], v[48:51], v[144:159]
ds_read_b64_tr_b16 v[32:33], v15 offset:32768
ds_read_b64_tr_b16 v[34:35], v15 offset:33792
v_mfma_f32_32x32x16_bf16 v[208:223], v[60:63], v[48:51], v[208:223]
ds_read_b64_tr_b16 v[36:37], v14 offset:49152
ds_read_b64_tr_b16 v[38:39], v14 offset:50176
s_add_u32 m0, s3, 147456
s_nop 0
buffer_load_dwordx4 v104, s[20:23], s34 offen lds
v_mfma_f32_32x32x16_bf16 v[160:175], v[56:59], v[44:47], v[160:175]
ds_read_b64_tr_b16 v[40:41], v15 offset:49152
ds_read_b64_tr_b16 v[42:43], v15 offset:50176
v_mfma_f32_32x32x16_bf16 v[224:239], v[64:67], v[44:47], v[224:239]
s_add_u32 m0, s43, 0
s_nop 0
buffer_load_dwordx4 v3, s[4:7], s48 offen offset:1024 lds
v_mfma_f32_32x32x16_bf16 v[176:191], v[56:59], v[48:51], v[176:191]
v_mfma_f32_32x32x16_bf16 v[240:255], v[64:67], v[48:51], v[240:255]
buffer_load_dwordx4 v4, s[4:7], s48 offen offset:2048 lds
s_waitcnt lgkmcnt(0)
v_mfma_f32_32x32x16_bf16 v[128:143], v[28:31], v[20:23], v[128:143]
ds_read_b128 v[44:47], v11 offset:16384
ds_read_b128 v[48:51], v11 offset:20480
s_waitcnt vmcnt(16)
v_and_b32 v108, 15, v1
v_lshrrev_b32 v109, 4, v1
v_mfma_f32_32x32x16_bf16 v[192:207], v[36:39], v[20:23], v[192:207]
ds_read_b64_tr_b16 v[52:53], v14 offset:36864
ds_read_b64_tr_b16 v[54:55], v14 offset:37888
v_lshrrev_b32 v110, 1, v109
v_lshlrev_b32 v110, 4, v110
buffer_load_dwordx4 v5, s[4:7], s48 offen offset:3072 lds
v_mfma_f32_32x32x16_bf16 v[144:159], v[28:31], v[24:27], v[144:159]
ds_read_b64_tr_b16 v[56:57], v15 offset:36864
ds_read_b64_tr_b16 v[58:59], v15 offset:37888
v_lshrrev_b32 v111, v110, v88
v_lshrrev_b32 v112, v110, v89
v_and_b32 v111, 0xffff, v111
v_mfma_f32_32x32x16_bf16 v[208:223], v[36:39], v[24:27], v[208:223]
ds_read_b64_tr_b16 v[60:61], v14 offset:53248
ds_read_b64_tr_b16 v[62:63], v14 offset:54272
v_and_b32 v112, 0xffff, v112
v_and_b32 v110, 1, v108
s_add_u32 m0, s3, 147456
s_nop 0
buffer_load_dwordx4 v105, s[20:23], s34 offen offset:1024 lds
v_mfma_f32_32x32x16_bf16 v[160:175], v[32:35], v[20:23], v[160:175]
ds_read_b64_tr_b16 v[64:65], v15 offset:53248
ds_read_b64_tr_b16 v[66:67], v15 offset:54272
v_lshlrev_b32 v110, 4, v110
v_lshlrev_b32 v111, v110, v111
v_lshlrev_b32 v112, v110, v112
v_mfma_f32_32x32x16_bf16 v[224:239], v[40:43], v[20:23], v[224:239]
v_lshrrev_b32 v110, 3, v108
v_and_b32 v113, 1, v109
s_add_u32 m0, s44, 0
s_add_u32 s48, s42, 688128
buffer_load_dwordx4 v6, s[8:11], s48 offen offset:0 lds
v_mfma_f32_32x32x16_bf16 v[176:191], v[32:35], v[24:27], v[176:191]
v_cmp_eq_u32 vcc, v110, v113
v_bfe_u32 v110, v108, 1, 2
s_nop 0
v_mfma_f32_32x32x16_bf16 v[240:255], v[40:43], v[24:27], v[240:255]
v_cndmask_b32 v111, 0, v111, vcc
v_cndmask_b32 v112, 0, v112, vcc
buffer_load_dwordx4 v7, s[8:11], s48 offen offset:1024 lds
s_waitcnt lgkmcnt(0)
v_mfma_f32_32x32x16_bf16 v[128:143], v[52:55], v[44:47], v[128:143]
ds_read_b128 v[20:23], v12 offset:16384
ds_read_b128 v[24:27], v12 offset:20480
v_cmp_eq_u32 vcc, 0, v110
s_nop 1
v_mfma_f32_32x32x16_bf16 v[192:207], v[60:63], v[44:47], v[192:207]
ds_read_b64_tr_b16 v[28:29], v14 offset:40960
ds_read_b64_tr_b16 v[30:31], v14 offset:41984
v_cndmask_b32 v72, 0, v111, vcc
v_cndmask_b32 v76, 0, v112, vcc
buffer_load_dwordx4 v8, s[8:11], s48 offen offset:2048 lds
v_mfma_f32_32x32x16_bf16 v[144:159], v[52:55], v[48:51], v[144:159]
ds_read_b64_tr_b16 v[32:33], v15 offset:40960
ds_read_b64_tr_b16 v[34:35], v15 offset:41984
v_cmp_eq_u32 vcc, 1, v110
s_nop 1
v_mfma_f32_32x32x16_bf16 v[208:223], v[60:63], v[48:51], v[208:223]
ds_read_b64_tr_b16 v[36:37], v14 offset:57344
ds_read_b64_tr_b16 v[38:39], v14 offset:58368
v_cndmask_b32 v73, 0, v111, vcc
v_cndmask_b32 v77, 0, v112, vcc
s_add_u32 m0, s3, 155648
s_nop 0
buffer_load_dwordx4 v104, s[24:27], s34 offen lds
v_mfma_f32_32x32x16_bf16 v[160:175], v[56:59], v[44:47], v[160:175]
ds_read_b64_tr_b16 v[40:41], v15 offset:57344
ds_read_b64_tr_b16 v[42:43], v15 offset:58368
v_cmp_eq_u32 vcc, 2, v110
s_nop 1
v_mfma_f32_32x32x16_bf16 v[224:239], v[64:67], v[44:47], v[224:239]
v_cndmask_b32 v74, 0, v111, vcc
v_cndmask_b32 v78, 0, v112, vcc
s_add_u32 m0, s44, 0
s_nop 0
buffer_load_dwordx4 v9, s[8:11], s48 offen offset:3072 lds
v_mfma_f32_32x32x16_bf16 v[176:191], v[56:59], v[48:51], v[176:191]
v_cmp_eq_u32 vcc, 3, v110
s_nop 1
v_mfma_f32_32x32x16_bf16 v[240:255], v[64:67], v[48:51], v[240:255]
v_cndmask_b32 v75, 0, v111, vcc
v_cndmask_b32 v79, 0, v112, vcc
s_add_u32 m0, s44, 16384
s_add_u32 s48, s42, 688128
buffer_load_dwordx4 v6, s[12:15], s48 offen offset:0 lds
s_waitcnt lgkmcnt(0)
v_mfma_f32_32x32x16_bf16 v[128:143], v[28:31], v[20:23], v[128:143]
ds_read_b128 v[44:47], v13 offset:16384
ds_read_b128 v[48:51], v13 offset:20480
v_mfma_f32_32x32x16_bf16 v[192:207], v[36:39], v[20:23], v[192:207]
ds_read_b64_tr_b16 v[52:53], v14 offset:45056
ds_read_b64_tr_b16 v[54:55], v14 offset:46080
buffer_load_dwordx4 v7, s[12:15], s48 offen offset:1024 lds
v_mfma_f32_32x32x16_bf16 v[144:159], v[28:31], v[24:27], v[144:159]
ds_read_b64_tr_b16 v[56:57], v15 offset:45056
ds_read_b64_tr_b16 v[58:59], v15 offset:46080
v_mfma_f32_32x32x16_bf16 v[208:223], v[36:39], v[24:27], v[208:223]
ds_read_b64_tr_b16 v[60:61], v14 offset:61440
ds_read_b64_tr_b16 v[62:63], v14 offset:62464
s_add_u32 m0, s3, 155648
s_nop 0
buffer_load_dwordx4 v105, s[24:27], s34 offen offset:1024 lds
v_mfma_f32_32x32x16_bf16 v[160:175], v[32:35], v[20:23], v[160:175]
ds_read_b64_tr_b16 v[64:65], v15 offset:61440
ds_read_b64_tr_b16 v[66:67], v15 offset:62464
v_mfma_f32_32x32x16_bf16 v[224:239], v[40:43], v[20:23], v[224:239]
s_add_u32 m0, s44, 16384
s_nop 0
buffer_load_dwordx4 v8, s[12:15], s48 offen offset:2048 lds
v_mfma_f32_32x32x16_bf16 v[176:191], v[32:35], v[24:27], v[176:191]
v_mfma_f32_32x32x16_bf16 v[240:255], v[40:43], v[24:27], v[240:255]
buffer_load_dwordx4 v9, s[12:15], s48 offen offset:3072 lds
s_waitcnt lgkmcnt(0)
s_waitcnt vmcnt(16)
s_barrier
v_mfma_f32_32x32x16_bf16 v[128:143], v[52:55], v[44:47], v[128:143]
ds_read_b128 v[20:23], v10 offset:32768
ds_read_b128 v[24:27], v10 offset:36864
v_mfma_f32_32x32x16_bf16 v[192:207], v[60:63], v[44:47], v[192:207]
ds_read_b64_tr_b16 v[28:29], v16 offset:0
ds_read_b64_tr_b16 v[30:31], v16 offset:1024
s_add_u32 m0, s43, 16384
s_add_u32 s48, s41, 512
buffer_load_dwordx4 v2, s[4:7], s48 offen offset:0 lds
v_mfma_f32_32x32x16_bf16 v[144:159], v[52:55], v[48:51], v[144:159]
ds_read_b64_tr_b16 v[32:33], v17 offset:0
ds_read_b64_tr_b16 v[34:35], v17 offset:1024
v_mfma_f32_32x32x16_bf16 v[208:223], v[60:63], v[48:51], v[208:223]
ds_read_b64_tr_b16 v[36:37], v16 offset:16384
ds_read_b64_tr_b16 v[38:39], v16 offset:17408
buffer_load_dwordx4 v[88:91], v107, s[20:23], s35 offen
v_mfma_f32_32x32x16_bf16 v[160:175], v[56:59], v[44:47], v[160:175]
ds_read_b64_tr_b16 v[40:41], v17 offset:16384
ds_read_b64_tr_b16 v[42:43], v17 offset:17408
v_mfma_f32_32x32x16_bf16 v[224:239], v[64:67], v[44:47], v[224:239]
buffer_load_dwordx4 v3, s[4:7], s48 offen offset:1024 lds
v_mfma_f32_32x32x16_bf16 v[176:191], v[56:59], v[48:51], v[176:191]
v_mfma_f32_32x32x16_bf16 v[240:255], v[64:67], v[48:51], v[240:255]
buffer_load_dwordx4 v4, s[4:7], s48 offen offset:2048 lds
s_waitcnt lgkmcnt(0)
v_mfma_f32_32x32x16_bf16 v[128:143], v[28:31], v[20:23], v[128:143]
ds_read_b128 v[44:47], v11 offset:32768
ds_read_b128 v[48:51], v11 offset:36864
v_lshrrev_b32 v112, 3, v1
v_and_b32 v113, 7, v1
v_bfe_u32 v114, v112, 1, 1
v_mfma_f32_32x32x16_bf16 v[192:207], v[36:39], v[20:23], v[192:207]
ds_read_b64_tr_b16 v[52:53], v16 offset:4096
ds_read_b64_tr_b16 v[54:55], v16 offset:5120
v_lshlrev_b32 v114, 2, v114
v_xor_b32 v113, v113, v114
buffer_load_dwordx4 v5, s[4:7], s48 offen offset:3072 lds
v_mfma_f32_32x32x16_bf16 v[144:159], v[28:31], v[24:27], v[144:159]
ds_read_b64_tr_b16 v[56:57], v17 offset:4096
ds_read_b64_tr_b16 v[58:59], v17 offset:5120
v_mul_u32_u24 v112, 896, v112
v_lshl_add_u32 v116, v113, 4, v112
v_add_u32 v117, 6144, v116
v_mfma_f32_32x32x16_bf16 v[208:223], v[36:39], v[24:27], v[208:223]
ds_read_b64_tr_b16 v[60:61], v16 offset:20480
ds_read_b64_tr_b16 v[62:63], v16 offset:21504
v_accvgpr_write_b32 a248, v116
v_accvgpr_write_b32 a249, v117
buffer_load_dwordx4 v[92:95], v106, s[20:23], s35 offen
v_mfma_f32_32x32x16_bf16 v[160:175], v[32:35], v[20:23], v[160:175]
ds_read_b64_tr_b16 v[64:65], v17 offset:20480
ds_read_b64_tr_b16 v[66:67], v17 offset:21504
v_lshrrev_b32 v112, 5, v1
v_bfe_u32 v113, v1, 2, 2
v_lshl_add_u32 v112, v112, 2, v113
v_mfma_f32_32x32x16_bf16 v[224:239], v[40:43], v[20:23], v[224:239]
v_lshlrev_b32 v112, 7, v112
v_bfe_u32 v114, v1, 4, 1
s_add_u32 m0, s44, 32768
s_add_u32 s48, s42, 917504
buffer_load_dwordx4 v6, s[8:11], s48 offen offset:0 lds
v_mfma_f32_32x32x16_bf16 v[176:191], v[32:35], v[24:27], v[176:191]
v_bfe_u32 v115, v1, 1, 1
v_lshl_add_u32 v114, v114, 1, v115
v_lshl_add_u32 v112, v114, 4, v112
v_mfma_f32_32x32x16_bf16 v[240:255], v[40:43], v[24:27], v[240:255]
v_and_b32 v114, 1, v1
v_lshl_add_u32 v112, v114, 3, v112
buffer_load_dwordx4 v7, s[8:11], s48 offen offset:1024 lds
s_waitcnt lgkmcnt(0)
v_mfma_f32_32x32x16_bf16 v[128:143], v[52:55], v[44:47], v[128:143]
ds_read_b128 v[20:23], v12 offset:32768
ds_read_b128 v[24:27], v12 offset:36864
v_bfe_u32 v113, v1, 3, 1
v_xor_b32 v113, s40, v113
v_mfma_f32_32x32x16_bf16 v[192:207], v[60:63], v[44:47], v[192:207]
ds_read_b64_tr_b16 v[28:29], v16 offset:8192
ds_read_b64_tr_b16 v[30:31], v16 offset:9216
v_lshl_add_u32 v116, v113, 6, v112
v_xor_b32 v113, 1, v113
buffer_load_dwordx4 v8, s[8:11], s48 offen offset:2048 lds
v_mfma_f32_32x32x16_bf16 v[144:159], v[52:55], v[48:51], v[144:159]
ds_read_b64_tr_b16 v[32:33], v17 offset:8192
ds_read_b64_tr_b16 v[34:35], v17 offset:9216
v_lshl_add_u32 v117, v113, 6, v112
s_mul_i32 s45, s36, 20480
v_mfma_f32_32x32x16_bf16 v[208:223], v[60:63], v[48:51], v[208:223]
ds_read_b64_tr_b16 v[36:37], v16 offset:24576
ds_read_b64_tr_b16 v[38:39], v16 offset:25600
v_add_u32 v112, s45, v116
v_add_u32 v113, s45, v117
v_mfma_f32_32x32x16_bf16 v[160:175], v[56:59], v[44:47], v[160:175]
ds_read_b64_tr_b16 v[40:41], v17 offset:24576
ds_read_b64_tr_b16 v[42:43], v17 offset:25600
v_accvgpr_write_b32 a250, v112
v_accvgpr_write_b32 a251, v113
buffer_load_dwordx4 v9, s[8:11], s48 offen offset:3072 lds
v_mfma_f32_32x32x16_bf16 v[224:239], v[64:67], v[44:47], v[224:239]
s_lshl_b32 s45, s36, 13
s_add_u32 s45, s45, 81920
v_mfma_f32_32x32x16_bf16 v[176:191], v[56:59], v[48:51], v[176:191]
v_add_u32 v112, s45, v116
v_add_u32 v113, s45, v117
v_mfma_f32_32x32x16_bf16 v[240:255], v[64:67], v[48:51], v[240:255]
v_accvgpr_write_b32 a252, v112
v_accvgpr_write_b32 a253, v113
s_add_u32 m0, s44, 49152
s_add_u32 s48, s42, 917504
buffer_load_dwordx4 v6, s[12:15], s48 offen offset:0 lds
s_waitcnt lgkmcnt(0)
v_mfma_f32_32x32x16_bf16 v[128:143], v[28:31], v[20:23], v[128:143]
ds_read_b128 v[44:47], v13 offset:32768
ds_read_b128 v[48:51], v13 offset:36864
s_lshl_b32 s45, s37, 2
s_lshl_b32 s46, s40, 1
v_mfma_f32_32x32x16_bf16 v[192:207], v[36:39], v[20:23], v[192:207]
ds_read_b64_tr_b16 v[52:53], v16 offset:12288
ds_read_b64_tr_b16 v[54:55], v16 offset:13312
s_add_u32 s45, s45, s46
buffer_load_dwordx4 v7, s[12:15], s48 offen offset:1024 lds
v_mfma_f32_32x32x16_bf16 v[144:159], v[28:31], v[24:27], v[144:159]
ds_read_b64_tr_b16 v[56:57], v17 offset:12288
ds_read_b64_tr_b16 v[58:59], v17 offset:13312
s_mul_i32 s45, s45, 112
v_mfma_f32_32x32x16_bf16 v[208:223], v[36:39], v[24:27], v[208:223]
ds_read_b64_tr_b16 v[60:61], v16 offset:28672
ds_read_b64_tr_b16 v[62:63], v16 offset:29696
s_lshl_b32 s46, s38, 3
v_mfma_f32_32x32x16_bf16 v[160:175], v[32:35], v[20:23], v[160:175]
ds_read_b64_tr_b16 v[64:65], v17 offset:28672
ds_read_b64_tr_b16 v[66:67], v17 offset:29696
s_add_u32 s45, s45, s46
s_lshl_b32 s46, s39, 2
buffer_load_dwordx4 v8, s[12:15], s48 offen offset:2048 lds
v_mfma_f32_32x32x16_bf16 v[224:239], v[40:43], v[20:23], v[224:239]
s_add_u32 s45, s45, s46
v_mfma_f32_32x32x16_bf16 v[176:191], v[32:35], v[24:27], v[176:191]
s_lshl_b32 s49, s45, 10
v_mfma_f32_32x32x16_bf16 v[240:255], v[40:43], v[24:27], v[240:255]
s_add_u32 s49, s49, 3997696
buffer_load_dwordx4 v9, s[12:15], s48 offen offset:3072 lds
s_waitcnt lgkmcnt(0)
s_waitcnt vmcnt(14)
s_waitcnt vmcnt(8)
s_barrier
v_mfma_f32_32x32x16_bf16 v[128:143], v[52:55], v[44:47], v[128:143]
ds_read_b128 v[20:23], v10 offset:0
ds_read_b128 v[24:27], v10 offset:4096
v_mfma_f32_32x32x16_bf16 v[192:207], v[60:63], v[44:47], v[192:207]
ds_read_b64_tr_b16 v[28:29], v14 offset:0
ds_read_b64_tr_b16 v[30:31], v14 offset:1024
s_add_u32 m0, s43, 32768
s_add_u32 s48, s41, 640
buffer_load_dwordx4 v2, s[4:7], s48 offen offset:0 lds
v_mfma_f32_32x32x16_bf16 v[144:159], v[52:55], v[48:51], v[144:159]
ds_read_b64_tr_b16 v[32:33], v15 offset:0
ds_read_b64_tr_b16 v[34:35], v15 offset:1024
v_mfma_f32_32x32x16_bf16 v[208:223], v[60:63], v[48:51], v[208:223]
ds_read_b64_tr_b16 v[36:37], v14 offset:16384
ds_read_b64_tr_b16 v[38:39], v14 offset:17408
v_mfma_f32_32x32x16_bf16 v[160:175], v[56:59], v[44:47], v[160:175]
ds_read_b64_tr_b16 v[40:41], v15 offset:16384
ds_read_b64_tr_b16 v[42:43], v15 offset:17408
buffer_load_dwordx4 v3, s[4:7], s48 offen offset:1024 lds
v_mfma_f32_32x32x16_bf16 v[224:239], v[64:67], v[44:47], v[224:239]
v_mfma_f32_32x32x16_bf16 v[176:191], v[56:59], v[48:51], v[176:191]
v_mfma_f32_32x32x16_bf16 v[240:255], v[64:67], v[48:51], v[240:255]
buffer_load_dwordx4 v4, s[4:7], s48 offen offset:2048 lds
s_waitcnt lgkmcnt(0)
v_mfma_f32_32x32x16_bf16 v[128:143], v[28:31], v[20:23], v[128:143]
ds_read_b128 v[44:47], v11 offset:0
ds_read_b128 v[48:51], v11 offset:4096
v_mfma_f32_32x32x16_bf16 v[192:207], v[36:39], v[20:23], v[192:207]
ds_read_b64_tr_b16 v[52:53], v14 offset:4096
ds_read_b64_tr_b16 v[54:55], v14 offset:5120
buffer_load_dwordx4 v5, s[4:7], s48 offen offset:3072 lds
v_mfma_f32_32x32x16_bf16 v[144:159], v[28:31], v[24:27], v[144:159]
ds_read_b64_tr_b16 v[56:57], v15 offset:4096
ds_read_b64_tr_b16 v[58:59], v15 offset:5120
v_mfma_f32_32x32x16_bf16 v[208:223], v[36:39], v[24:27], v[208:223]
ds_read_b64_tr_b16 v[60:61], v14 offset:20480
ds_read_b64_tr_b16 v[62:63], v14 offset:21504
v_mfma_f32_32x32x16_bf16 v[160:175], v[32:35], v[20:23], v[160:175]
ds_read_b64_tr_b16 v[64:65], v15 offset:20480
ds_read_b64_tr_b16 v[66:67], v15 offset:21504
ds_read_b128 v[96:99], v80 offset:128
ds_read_b128 v[100:103], v80 offset:0
ds_read_b128 v[104:107], v80 offset:384
s_add_u32 m0, s44, 65536
s_add_u32 s48, s42, 1146880
buffer_load_dwordx4 v6, s[8:11], s48 offen offset:0 lds
v_mfma_f32_32x32x16_bf16 v[224:239], v[40:43], v[20:23], v[224:239]
ds_read_b128 v[108:111], v80 offset:256
ds_read_b128 v[112:115], v80 offset:640
v_mfma_f32_32x32x16_bf16 v[176:191], v[32:35], v[24:27], v[176:191]
ds_read_b128 v[116:119], v80 offset:512
ds_read_b64_tr_b16 v[120:121], v81 offset:0
ds_read_b64_tr_b16 v[122:123], v81 offset:256
v_mfma_f32_32x32x16_bf16 v[240:255], v[40:43], v[24:27], v[240:255]
ds_read_b64_tr_b16 v[124:125], v81 offset:512
ds_read_b64_tr_b16 v[126:127], v81 offset:768
buffer_load_dwordx4 v7, s[8:11], s48 offen offset:1024 lds
s_waitcnt lgkmcnt(10)
v_mfma_f32_32x32x16_bf16 v[128:143], v[52:55], v[44:47], v[128:143]
ds_read_b128 v[20:23], v12 offset:0
ds_read_b128 v[24:27], v12 offset:4096
s_waitcnt lgkmcnt(2)
v_mfma_f32_16x16x32_bf16 v[68:71], v[88:91], v[72:75], 0
v_mfma_f32_16x16x32_bf16 v[68:71], v[92:95], v[76:79], v[68:71]
v_mfma_f32_16x16x32_bf16 v[88:91], v[96:99], v[72:75], 0
v_mfma_f32_32x32x16_bf16 v[192:207], v[60:63], v[44:47], v[192:207]
ds_read_b64_tr_b16 v[28:29], v14 offset:8192
ds_read_b64_tr_b16 v[30:31], v14 offset:9216
v_mfma_f32_16x16x32_bf16 v[88:91], v[100:103], v[76:79], v[88:91]
v_mfma_f32_16x16x32_bf16 v[92:95], v[104:107], v[72:75], 0
v_mfma_f32_16x16x32_bf16 v[92:95], v[108:111], v[76:79], v[92:95]
buffer_load_dwordx4 v8, s[8:11], s48 offen offset:2048 lds
v_mfma_f32_32x32x16_bf16 v[144:159], v[52:55], v[48:51], v[144:159]
ds_read_b64_tr_b16 v[32:33], v15 offset:8192
ds_read_b64_tr_b16 v[34:35], v15 offset:9216
v_mfma_f32_16x16x32_bf16 v[96:99], v[112:115], v[72:75], 0
v_mfma_f32_16x16x32_bf16 v[96:99], v[116:119], v[76:79], v[96:99]
v_lshlrev_b32 v100, 16, v120
v_mfma_f32_32x32x16_bf16 v[208:223], v[60:63], v[48:51], v[208:223]
ds_read_b64_tr_b16 v[36:37], v14 offset:24576
ds_read_b64_tr_b16 v[38:39], v14 offset:25600
v_and_b32 v101, 0xffff0000, v120
v_lshlrev_b32 v102, 16, v121
v_and_b32 v103, 0xffff0000, v121
v_mfma_f32_32x32x16_bf16 v[160:175], v[56:59], v[44:47], v[160:175]
ds_read_b64_tr_b16 v[40:41], v15 offset:24576
ds_read_b64_tr_b16 v[42:43], v15 offset:25600
v_lshlrev_b32 v104, 16, v122
v_and_b32 v105, 0xffff0000, v122
v_lshlrev_b32 v106, 16, v123
buffer_load_dwordx4 v9, s[8:11], s48 offen offset:3072 lds
v_mfma_f32_32x32x16_bf16 v[224:239], v[64:67], v[44:47], v[224:239]
v_and_b32 v107, 0xffff0000, v123
v_lshlrev_b32 v108, 16, v124
v_and_b32 v109, 0xffff0000, v124
v_mfma_f32_32x32x16_bf16 v[176:191], v[56:59], v[48:51], v[176:191]
v_lshlrev_b32 v110, 16, v125
v_and_b32 v111, 0xffff0000, v125
v_lshlrev_b32 v112, 16, v126
v_mfma_f32_32x32x16_bf16 v[240:255], v[64:67], v[48:51], v[240:255]
v_and_b32 v113, 0xffff0000, v126
v_lshlrev_b32 v114, 16, v127
v_and_b32 v115, 0xffff0000, v127
s_add_u32 m0, s44, 81920
s_add_u32 s48, s42, 1146880
buffer_load_dwordx4 v6, s[12:15], s48 offen offset:0 lds
s_waitcnt lgkmcnt(0)
v_mfma_f32_32x32x16_bf16 v[128:143], v[28:31], v[20:23], v[128:143]
ds_read_b128 v[44:47], v13 offset:0
ds_read_b128 v[48:51], v13 offset:4096
v_mul_f32 v68, v68, v100
v_mul_f32 v69, v69, v101
v_mul_f32 v70, v70, v102
v_mfma_f32_32x32x16_bf16 v[192:207], v[36:39], v[20:23], v[192:207]
ds_read_b64_tr_b16 v[52:53], v14 offset:12288
ds_read_b64_tr_b16 v[54:55], v14 offset:13312
v_mul_f32 v71, v71, v103
v_mul_f32 v88, v88, v104
v_mul_f32 v89, v89, v105
buffer_load_dwordx4 v7, s[12:15], s48 offen offset:1024 lds
v_mfma_f32_32x32x16_bf16 v[144:159], v[28:31], v[24:27], v[144:159]
ds_read_b64_tr_b16 v[56:57], v15 offset:12288
ds_read_b64_tr_b16 v[58:59], v15 offset:13312
v_mul_f32 v90, v90, v106
v_mul_f32 v91, v91, v107
v_mul_f32 v92, v92, v108
v_mfma_f32_32x32x16_bf16 v[208:223], v[36:39], v[24:27], v[208:223]
ds_read_b64_tr_b16 v[60:61], v14 offset:28672
ds_read_b64_tr_b16 v[62:63], v14 offset:29696
v_mul_f32 v93, v93, v109
v_mul_f32 v94, v94, v110
v_mul_f32 v95, v95, v111
v_mfma_f32_32x32x16_bf16 v[160:175], v[32:35], v[20:23], v[160:175]
ds_read_b64_tr_b16 v[64:65], v15 offset:28672
ds_read_b64_tr_b16 v[66:67], v15 offset:29696
v_mul_f32 v96, v96, v112
v_mul_f32 v97, v97, v113
v_mul_f32 v98, v98, v114
buffer_load_dwordx4 v8, s[12:15], s48 offen offset:2048 lds
v_mfma_f32_32x32x16_bf16 v[224:239], v[40:43], v[20:23], v[224:239]
v_mul_f32 v99, v99, v115
v_cvt_pk_bf16_f32 v116, v99, v98
v_cvt_pk_bf16_f32 v117, v97, v96
v_mfma_f32_32x32x16_bf16 v[176:191], v[32:35], v[24:27], v[176:191]
v_cvt_pk_bf16_f32 v118, v95, v94
v_cvt_pk_bf16_f32 v119, v93, v92
v_cvt_pk_bf16_f32 v120, v91, v90
v_mfma_f32_32x32x16_bf16 v[240:255], v[40:43], v[24:27], v[240:255]
v_cvt_pk_bf16_f32 v121, v89, v88
v_cvt_pk_bf16_f32 v122, v71, v70
v_cvt_pk_bf16_f32 v123, v69, v68
buffer_load_dwordx4 v9, s[12:15], s48 offen offset:3072 lds
s_waitcnt lgkmcnt(0)
s_waitcnt vmcnt(12)
s_barrier
v_mfma_f32_32x32x16_bf16 v[128:143], v[52:55], v[44:47], v[128:143]
ds_read_b128 v[20:23], v10 offset:16384
ds_read_b128 v[24:27], v10 offset:20480
v_mfma_f32_32x32x16_bf16 v[192:207], v[60:63], v[44:47], v[192:207]
ds_read_b64_tr_b16 v[28:29], v14 offset:32768
ds_read_b64_tr_b16 v[30:31], v14 offset:33792
s_add_u32 m0, s43, 0
s_add_u32 s48, s41, 768
buffer_load_dwordx4 v2, s[4:7], s48 offen offset:0 lds
v_mfma_f32_32x32x16_bf16 v[144:159], v[52:55], v[48:51], v[144:159]
ds_read_b64_tr_b16 v[32:33], v15 offset:32768
ds_read_b64_tr_b16 v[34:35], v15 offset:33792
v_mfma_f32_32x32x16_bf16 v[208:223], v[60:63], v[48:51], v[208:223]
ds_read_b64_tr_b16 v[36:37], v14 offset:49152
ds_read_b64_tr_b16 v[38:39], v14 offset:50176
v_mfma_f32_32x32x16_bf16 v[160:175], v[56:59], v[44:47], v[160:175]
ds_read_b64_tr_b16 v[40:41], v15 offset:49152
ds_read_b64_tr_b16 v[42:43], v15 offset:50176
buffer_load_dwordx4 v3, s[4:7], s48 offen offset:1024 lds
v_mfma_f32_32x32x16_bf16 v[224:239], v[64:67], v[44:47], v[224:239]
v_mfma_f32_32x32x16_bf16 v[176:191], v[56:59], v[48:51], v[176:191]
v_mfma_f32_32x32x16_bf16 v[240:255], v[64:67], v[48:51], v[240:255]
buffer_load_dwordx4 v4, s[4:7], s48 offen offset:2048 lds
s_waitcnt lgkmcnt(0)
v_mfma_f32_32x32x16_bf16 v[128:143], v[28:31], v[20:23], v[128:143]
ds_read_b128 v[44:47], v11 offset:16384
ds_read_b128 v[48:51], v11 offset:20480
ds_write_b128 v82, v[116:119]
v_mfma_f32_32x32x16_bf16 v[192:207], v[36:39], v[20:23], v[192:207]
ds_read_b64_tr_b16 v[52:53], v14 offset:36864
ds_read_b64_tr_b16 v[54:55], v14 offset:37888
buffer_load_dwordx4 v5, s[4:7], s48 offen offset:3072 lds
v_mfma_f32_32x32x16_bf16 v[144:159], v[28:31], v[24:27], v[144:159]
ds_read_b64_tr_b16 v[56:57], v15 offset:36864
ds_read_b64_tr_b16 v[58:59], v15 offset:37888
ds_write_b128 v83, v[120:123]
v_mfma_f32_32x32x16_bf16 v[208:223], v[36:39], v[24:27], v[208:223]
ds_read_b64_tr_b16 v[60:61], v14 offset:53248
ds_read_b64_tr_b16 v[62:63], v14 offset:54272
v_mfma_f32_32x32x16_bf16 v[160:175], v[32:35], v[20:23], v[160:175]
ds_read_b64_tr_b16 v[64:65], v15 offset:53248
ds_read_b64_tr_b16 v[66:67], v15 offset:54272
ds_read_b128 v[116:119], v84
s_add_u32 m0, s44, 0
s_add_u32 s48, s42, 1376256
buffer_load_dwordx4 v6, s[8:11], s48 offen offset:0 lds
v_mfma_f32_32x32x16_bf16 v[224:239], v[40:43], v[20:23], v[224:239]
v_mfma_f32_32x32x16_bf16 v[176:191], v[32:35], v[24:27], v[176:191]
ds_read_b128 v[120:123], v84 offset:1024
v_mfma_f32_32x32x16_bf16 v[240:255], v[40:43], v[24:27], v[240:255]
buffer_load_dwordx4 v7, s[8:11], s48 offen offset:1024 lds
s_waitcnt lgkmcnt(2)
v_mfma_f32_32x32x16_bf16 v[128:143], v[52:55], v[44:47], v[128:143]
ds_read_b128 v[20:23], v12 offset:16384
ds_read_b128 v[24:27], v12 offset:20480
v_mfma_f32_32x32x16_bf16 v[192:207], v[60:63], v[44:47], v[192:207]
ds_read_b64_tr_b16 v[28:29], v14 offset:40960
ds_read_b64_tr_b16 v[30:31], v14 offset:41984
buffer_load_dwordx4 v8, s[8:11], s48 offen offset:2048 lds
v_mfma_f32_32x32x16_bf16 v[144:159], v[52:55], v[48:51], v[144:159]
ds_read_b64_tr_b16 v[32:33], v15 offset:40960
ds_read_b64_tr_b16 v[34:35], v15 offset:41984
v_mfma_f32_32x32x16_bf16 v[208:223], v[60:63], v[48:51], v[208:223]
ds_read_b64_tr_b16 v[36:37], v14 offset:57344
ds_read_b64_tr_b16 v[38:39], v14 offset:58368
s_waitcnt lgkmcnt(8)
buffer_store_dwordx4 v[116:119], v85, s[16:19], s94 offen sc1
v_mfma_f32_32x32x16_bf16 v[160:175], v[56:59], v[44:47], v[160:175]
ds_read_b64_tr_b16 v[40:41], v15 offset:57344
ds_read_b64_tr_b16 v[42:43], v15 offset:58368
v_mfma_f32_32x32x16_bf16 v[224:239], v[64:67], v[44:47], v[224:239]
buffer_load_dwordx4 v9, s[8:11], s48 offen offset:3072 lds
v_mfma_f32_32x32x16_bf16 v[176:191], v[56:59], v[48:51], v[176:191]
v_mfma_f32_32x32x16_bf16 v[240:255], v[64:67], v[48:51], v[240:255]
s_add_u32 m0, s44, 16384
s_add_u32 s48, s42, 1376256
buffer_load_dwordx4 v6, s[12:15], s48 offen offset:0 lds
s_waitcnt lgkmcnt(0)
v_mfma_f32_32x32x16_bf16 v[128:143], v[28:31], v[20:23], v[128:143]
ds_read_b128 v[44:47], v13 offset:16384
ds_read_b128 v[48:51], v13 offset:20480
v_mfma_f32_32x32x16_bf16 v[192:207], v[36:39], v[20:23], v[192:207]
ds_read_b64_tr_b16 v[52:53], v14 offset:45056
ds_read_b64_tr_b16 v[54:55], v14 offset:46080
buffer_load_dwordx4 v7, s[12:15], s48 offen offset:1024 lds
v_mfma_f32_32x32x16_bf16 v[144:159], v[28:31], v[24:27], v[144:159]
ds_read_b64_tr_b16 v[56:57], v15 offset:45056
ds_read_b64_tr_b16 v[58:59], v15 offset:46080
v_mfma_f32_32x32x16_bf16 v[208:223], v[36:39], v[24:27], v[208:223]
ds_read_b64_tr_b16 v[60:61], v14 offset:61440
ds_read_b64_tr_b16 v[62:63], v14 offset:62464
buffer_store_dwordx4 v[120:123], v85, s[16:19], s95 offen sc1
v_mfma_f32_32x32x16_bf16 v[160:175], v[32:35], v[20:23], v[160:175]
ds_read_b64_tr_b16 v[64:65], v15 offset:61440
ds_read_b64_tr_b16 v[66:67], v15 offset:62464
v_mfma_f32_32x32x16_bf16 v[224:239], v[40:43], v[20:23], v[224:239]
buffer_load_dwordx4 v8, s[12:15], s48 offen offset:2048 lds
v_mfma_f32_32x32x16_bf16 v[176:191], v[32:35], v[24:27], v[176:191]
v_mfma_f32_32x32x16_bf16 v[240:255], v[40:43], v[24:27], v[240:255]
buffer_load_dwordx4 v9, s[12:15], s48 offen offset:3072 lds
s_waitcnt lgkmcnt(0)
s_waitcnt vmcnt(14)
s_barrier
v_mfma_f32_32x32x16_bf16 v[128:143], v[52:55], v[44:47], v[128:143]
ds_read_b128 v[20:23], v10 offset:32768
ds_read_b128 v[24:27], v10 offset:36864
s_mul_i32 s42, s36, 401408
s_lshl_b32 s45, s53, 7
v_mfma_f32_32x32x16_bf16 v[192:207], v[60:63], v[44:47], v[192:207]
ds_read_b64_tr_b16 v[28:29], v16 offset:0
ds_read_b64_tr_b16 v[30:31], v16 offset:1024
s_add_u32 s42, s42, s45
s_mul_i32 s43, s36, 20480
v_mfma_f32_32x32x16_bf16 v[144:159], v[52:55], v[48:51], v[144:159]
ds_read_b64_tr_b16 v[32:33], v17 offset:0
ds_read_b64_tr_b16 v[34:35], v17 offset:1024
s_lshl_b32 s33, s36, 13
s_add_u32 s33, s33, 81920
v_mfma_f32_32x32x16_bf16 v[208:223], v[60:63], v[48:51], v[208:223]
ds_read_b64_tr_b16 v[36:37], v16 offset:16384
ds_read_b64_tr_b16 v[38:39], v16 offset:17408
v_accvgpr_read_b32 v120, a248
v_accvgpr_read_b32 v121, a249
v_mfma_f32_32x32x16_bf16 v[160:175], v[56:59], v[44:47], v[160:175]
ds_read_b64_tr_b16 v[40:41], v17 offset:16384
ds_read_b64_tr_b16 v[42:43], v17 offset:17408
v_accvgpr_read_b32 v122, a250
v_accvgpr_read_b32 v123, a251
v_mfma_f32_32x32x16_bf16 v[224:239], v[64:67], v[44:47], v[224:239]
v_accvgpr_read_b32 v118, a252
v_accvgpr_read_b32 v119, a253
v_mfma_f32_32x32x16_bf16 v[176:191], v[56:59], v[48:51], v[176:191]
s_add_u32 s29, s42, 401408
s_mov_b32 s28, s42
v_mfma_f32_32x32x16_bf16 v[240:255], v[64:67], v[48:51], v[240:255]
v_subrev_u32 v116, 65536, v118
v_subrev_u32 v117, 65536, v119
s_waitcnt lgkmcnt(0)
v_mfma_f32_32x32x16_bf16 v[128:143], v[28:31], v[20:23], v[128:143]
ds_read_b128 v[44:47], v11 offset:32768
ds_read_b128 v[48:51], v11 offset:36864
s_add_u32 m0, s33, 0
s_mov_b32 s48, s28
s_add_u32 s28, s28, 14336
s_cmp_eq_u32 s28, s29
s_cselect_b32 s28, s42, s28
buffer_load_dwordx4 v120, s[56:59], s48 offen lds
v_mfma_f32_32x32x16_bf16 v[192:207], v[36:39], v[20:23], v[192:207]
ds_read_b64_tr_b16 v[52:53], v16 offset:4096
ds_read_b64_tr_b16 v[54:55], v16 offset:5120
v_mfma_f32_32x32x16_bf16 v[144:159], v[28:31], v[24:27], v[144:159]
ds_read_b64_tr_b16 v[56:57], v17 offset:4096
ds_read_b64_tr_b16 v[58:59], v17 offset:5120
s_add_u32 m0, s33, 0
s_nop 0
buffer_load_dwordx4 v121, s[56:59], s48 offen offset:1024 lds
v_mfma_f32_32x32x16_bf16 v[208:223], v[36:39], v[24:27], v[208:223]
ds_read_b64_tr_b16 v[60:61], v16 offset:20480
ds_read_b64_tr_b16 v[62:63], v16 offset:21504
v_mfma_f32_32x32x16_bf16 v[160:175], v[32:35], v[20:23], v[160:175]
ds_read_b64_tr_b16 v[64:65], v17 offset:20480
ds_read_b64_tr_b16 v[66:67], v17 offset:21504
s_add_u32 m0, s33, 2048
s_mov_b32 s48, s28
s_add_u32 s28, s28, 14336
s_cmp_eq_u32 s28, s29
s_cselect_b32 s28, s42, s28
buffer_load_dwordx4 v120, s[56:59], s48 offen lds
v_min_u32 v126, 31, v1
v_mfma_f32_32x32x16_bf16 v[224:239], v[40:43], v[20:23], v[224:239]
v_lshlrev_b32 v126, 6, v126
v_mfma_f32_32x32x16_bf16 v[176:191], v[32:35], v[24:27], v[176:191]
s_add_u32 m0, s33, 2048
s_nop 0
buffer_load_dwordx4 v121, s[56:59], s48 offen offset:1024 lds
s_mov_b32 s55, 4096
v_mfma_f32_32x32x16_bf16 v[240:255], v[40:43], v[24:27], v[240:255]
s_waitcnt lgkmcnt(0)
v_mfma_f32_32x32x16_bf16 v[128:143], v[52:55], v[44:47], v[128:143]
ds_read_b128 v[20:23], v12 offset:32768
ds_read_b128 v[24:27], v12 offset:36864
v_and_b32 v96, 15, v1
v_lshrrev_b32 v97, 4, v1
v_add_u32 v98, 1, v96
v_and_b32 v99, 3, v98
v_mfma_f32_32x32x16_bf16 v[192:207], v[60:63], v[44:47], v[192:207]
ds_read_b64_tr_b16 v[28:29], v16 offset:8192
ds_read_b64_tr_b16 v[30:31], v16 offset:9216
v_mul_u32_u24 v99, 4160, v99
v_lshrrev_b32 v98, 2, v98
v_lshl_add_u32 v99, v98, 3, v99
v_lshl_add_u32 v99, v97, 4, v99
v_mfma_f32_32x32x16_bf16 v[144:159], v[52:55], v[48:51], v[144:159]
ds_read_b64_tr_b16 v[32:33], v17 offset:8192
ds_read_b64_tr_b16 v[34:35], v17 offset:9216
s_mul_i32 s98, s40, 16640
s_add_u32 s98, s98, 114688
v_add_u32 v124, s98, v99
v_mfma_f32_32x32x16_bf16 v[208:223], v[60:63], v[48:51], v[208:223]
ds_read_b64_tr_b16 v[36:37], v16 offset:24576
ds_read_b64_tr_b16 v[38:39], v16 offset:25600
v_lshlrev_b32 v98, 5, v96
v_lshlrev_b32 v99, 4, v97
v_sub_u32 v99, v99, v98
s_mul_i32 s98, s40, 5120
v_mfma_f32_32x32x16_bf16 v[160:175], v[56:59], v[44:47], v[160:175]
ds_read_b64_tr_b16 v[40:41], v17 offset:24576
ds_read_b64_tr_b16 v[42:43], v17 offset:25600
s_lshl_b32 s99, s39, 9
s_sub_u32 s98, s98, s99
s_add_u32 s98, s98, 153568
v_add_u32 v125, s98, v99
buffer_load_dword v127, v126, s[16:19], s55 offen sc1
v_mfma_f32_32x32x16_bf16 v[224:239], v[64:67], v[44:47], v[224:239]
s_lshl_b32 s32, s37, 4
s_add_u32 s32, s32, s38
s_lshl_b32 s32, s32, 2
v_mfma_f32_32x32x16_bf16 v[176:191], v[56:59], v[48:51], v[176:191]
s_add_u32 s32, s32, s36
s_lshl_b32 s32, s32, 6
s_add_u32 s32, s32, 65536
s_add_u32 m0, s33, 4096
s_mov_b32 s48, s28
s_add_u32 s28, s28, 14336
s_cmp_eq_u32 s28, s29
s_cselect_b32 s28, s42, s28
buffer_load_dwordx4 v120, s[56:59], s48 offen lds
v_mfma_f32_32x32x16_bf16 v[240:255], v[64:67], v[48:51], v[240:255]
s_add_u32 m0, s33, 4096
s_nop 0
buffer_load_dwordx4 v121, s[56:59], s48 offen offset:1024 lds
s_add_u32 m0, s33, 6144
s_mov_b32 s48, s28
s_add_u32 s28, s28, 14336
s_cmp_eq_u32 s28, s29
s_cselect_b32 s28, s42, s28
buffer_load_dwordx4 v120, s[56:59], s48 offen lds
s_add_u32 m0, s33, 6144
s_nop 0
buffer_load_dwordx4 v121, s[56:59], s48 offen offset:1024 lds
s_waitcnt lgkmcnt(0)
v_mfma_f32_32x32x16_bf16 v[128:143], v[28:31], v[20:23], v[128:143]
ds_read_b128 v[44:47], v13 offset:32768
ds_read_b128 v[48:51], v13 offset:36864
v_lshrrev_b32 v71, 5, v1
v_mfma_f32_32x32x16_bf16 v[192:207], v[36:39], v[20:23], v[192:207]
ds_read_b64_tr_b16 v[52:53], v16 offset:12288
ds_read_b64_tr_b16 v[54:55], v16 offset:13312
v_mul_u32_u24 v71, 6656, v71
s_waitcnt vmcnt(11)
v_mov_b32 v86, 0
v_mov_b32 v87, s50
s_mov_b64 exec, 1
buffer_store_dword v87, v86, s[16:19], s32 offen sc1
s_mov_b64 exec, -1
v_mfma_f32_32x32x16_bf16 v[144:159], v[28:31], v[24:27], v[144:159]
ds_read_b64_tr_b16 v[56:57], v17 offset:12288
ds_read_b64_tr_b16 v[58:59], v17 offset:13312
v_add_u32 v71, v71, v18
v_mfma_f32_32x32x16_bf16 v[208:223], v[36:39], v[24:27], v[208:223]
ds_read_b64_tr_b16 v[60:61], v16 offset:28672
ds_read_b64_tr_b16 v[62:63], v16 offset:29696
s_mov_b32 s8, s64
v_mfma_f32_32x32x16_bf16 v[160:175], v[32:35], v[20:23], v[160:175]
ds_read_b64_tr_b16 v[64:65], v17 offset:28672
ds_read_b64_tr_b16 v[66:67], v17 offset:29696
s_and_b32 s9, s65, 0xffff
v_lshlrev_b32 v70, 4, v0
v_mfma_f32_32x32x16_bf16 v[224:239], v[40:43], v[20:23], v[224:239]
s_mov_b32 s10, 1835008
s_lshl_b32 s54, s2, 13
v_mfma_f32_32x32x16_bf16 v[176:191], v[32:35], v[24:27], v[176:191]
s_mov_b32 s11, 0x20000
buffer_load_dwordx4 a[224:227], v70, s[60:63], s54 offen
v_mfma_f32_32x32x16_bf16 v[240:255], v[40:43], v[24:27], v[240:255]
buffer_load_dwordx2 a[228:229], v70, s[60:63], s54 offen offset:16
s_waitcnt lgkmcnt(0)
s_waitcnt vmcnt(12)
s_barrier
v_mfma_f32_32x32x16_bf16 v[128:143], v[52:55], v[44:47], v[128:143]
ds_read_b128 v[20:23], v10 offset:0
ds_read_b128 v[24:27], v10 offset:4096
s_mul_i32 s90, s40, 16640
s_mul_i32 s91, s39, 8320
v_mfma_f32_32x32x16_bf16 v[192:207], v[60:63], v[44:47], v[192:207]
ds_read_b64_tr_b16 v[28:29], v14 offset:0
ds_read_b64_tr_b16 v[30:31], v14 offset:1024
s_add_u32 s90, s90, s91
v_mfma_f32_32x32x16_bf16 v[144:159], v[52:55], v[48:51], v[144:159]
ds_read_b64_tr_b16 v[32:33], v15 offset:0
ds_read_b64_tr_b16 v[34:35], v15 offset:1024
s_add_u32 s90, s90, 114720
v_mfma_f32_32x32x16_bf16 v[208:223], v[60:63], v[48:51], v[208:223]
ds_read_b64_tr_b16 v[36:37], v14 offset:16384
ds_read_b64_tr_b16 v[38:39], v14 offset:17408
s_lshl_b32 s91, s2, 13
v_mfma_f32_32x32x16_bf16 v[160:175], v[56:59], v[44:47], v[160:175]
ds_read_b64_tr_b16 v[40:41], v15 offset:16384
ds_read_b64_tr_b16 v[42:43], v15 offset:17408
s_lshl_b32 s46, s40, 12
s_add_u32 s54, s54, 4096
v_mfma_f32_32x32x16_bf16 v[224:239], v[64:67], v[44:47], v[224:239]
s_add_u32 s91, s91, s46
buffer_load_dwordx4 a[232:235], v70, s[60:63], s54 offen
v_mfma_f32_32x32x16_bf16 v[176:191], v[56:59], v[48:51], v[176:191]
s_lshl_b32 s46, s39, 2
buffer_load_dwordx2 a[236:237], v70, s[60:63], s54 offen offset:16
v_mfma_f32_32x32x16_bf16 v[240:255], v[64:67], v[48:51], v[240:255]
s_add_u32 s91, s91, s46
s_waitcnt lgkmcnt(0)
v_mfma_f32_32x32x16_bf16 v[128:143], v[28:31], v[20:23], v[128:143]
ds_read_b128 v[44:47], v11 offset:0
ds_read_b128 v[48:51], v11 offset:4096
s_waitcnt vmcnt(9)
v_cmp_ne_u32 vcc, s50, v127
s_cbranch_vccz G_p1_done
    s_mov_b32 s51, 0x8000
    G_p1_loop:
    buffer_load_dword v127, v126, s[16:19], s55 offen sc1
    s_waitcnt vmcnt(0)
    v_cmp_ne_u32 vcc, s50, v127
    s_cbranch_vccz G_p1_done
    s_sleep 1
    s_sub_u32 s51, s51, 1
    s_cmp_lg_u32 s51, 0
    s_cbranch_scc1 G_p1_loop
    G_p1_done:

v_mfma_f32_32x32x16_bf16 v[192:207], v[36:39], v[20:23], v[192:207]
ds_read_b64_tr_b16 v[52:53], v14 offset:4096
ds_read_b64_tr_b16 v[54:55], v14 offset:5120
s_add_u32 m0, s90, 0
s_add_u32 s46, s91, 0
buffer_load_dwordx4 v18, s[60:63], s46 offen lds
v_mfma_f32_32x32x16_bf16 v[144:159], v[28:31], v[24:27], v[144:159]
ds_read_b64_tr_b16 v[56:57], v15 offset:4096
ds_read_b64_tr_b16 v[58:59], v15 offset:5120
s_mov_b32 m0, 18432
s_lshl_b32 s46, s37, 10
s_add_u32 s46, s46, 262144
buffer_load_dwordx4 v18, s[16:19], s46 offen sc1 lds
v_mfma_f32_32x32x16_bf16 v[208:223], v[36:39], v[24:27], v[208:223]
ds_read_b64_tr_b16 v[60:61], v14 offset:20480
ds_read_b64_tr_b16 v[62:63], v14 offset:21504
s_add_u32 m0, s90, 1024
s_add_u32 s46, s91, 1024
buffer_load_dwordx4 v18, s[60:63], s46 offen lds
v_mfma_f32_32x32x16_bf16 v[160:175], v[32:35], v[20:23], v[160:175]
ds_read_b64_tr_b16 v[64:65], v15 offset:20480
ds_read_b64_tr_b16 v[66:67], v15 offset:21504
s_waitcnt vmcnt(13)
ds_read_b64_tr_b16 a[0:1], v118 offset:0
ds_read_b64_tr_b16 a[2:3], v118 offset:1024
v_mfma_f32_32x32x16_bf16 v[224:239], v[40:43], v[20:23], v[224:239]
s_mov_b32 m0, 19456
s_lshl_b32 s46, s38, 9
s_add_u32 s46, s46, 278528
buffer_load_dwordx4 v71, s[16:19], s46 offen sc1 lds
ds_read_b64_tr_b16 a[4:5], v119 offset:0
ds_read_b64_tr_b16 a[6:7], v119 offset:1024
v_mfma_f32_32x32x16_bf16 v[176:191], v[32:35], v[24:27], v[176:191]
ds_read_b64_tr_b16 a[8:9], v118 offset:2048
ds_read_b64_tr_b16 a[10:11], v118 offset:3072
v_mfma_f32_32x32x16_bf16 v[240:255], v[40:43], v[24:27], v[240:255]
ds_read_b64_tr_b16 a[12:13], v119 offset:2048
ds_read_b64_tr_b16 a[14:15], v119 offset:3072
s_waitcnt lgkmcnt(8)
v_mfma_f32_32x32x16_bf16 v[128:143], v[52:55], v[44:47], v[128:143]
ds_read_b128 v[20:23], v12 offset:0
ds_read_b128 v[24:27], v12 offset:4096
v_min_u32 v126, 31, v1
v_lshrrev_b32 v127, 1, v126
v_mfma_f32_32x32x16_bf16 v[192:207], v[60:63], v[44:47], v[192:207]
ds_read_b64_tr_b16 v[28:29], v14 offset:8192
ds_read_b64_tr_b16 v[30:31], v14 offset:9216
v_and_b32 v126, 1, v126
s_add_u32 m0, s90, 2048
s_add_u32 s46, s91, 2048
buffer_load_dwordx4 v18, s[60:63], s46 offen lds
v_mfma_f32_32x32x16_bf16 v[144:159], v[52:55], v[48:51], v[144:159]
ds_read_b64_tr_b16 v[32:33], v15 offset:8192
ds_read_b64_tr_b16 v[34:35], v15 offset:9216
v_lshlrev_b32 v126, 7, v126
v_lshl_add_u32 v126, v127, 12, v126
v_mfma_f32_32x32x16_bf16 v[208:223], v[60:63], v[48:51], v[208:223]
ds_read_b64_tr_b16 v[36:37], v14 offset:24576
ds_read_b64_tr_b16 v[38:39], v14 offset:25600
s_lshr_b32 s55, s2, 4
s_add_u32 m0, s90, 3072
s_add_u32 s46, s91, 3072
buffer_load_dwordx4 v18, s[60:63], s46 offen lds
v_mfma_f32_32x32x16_bf16 v[160:175], v[56:59], v[44:47], v[160:175]
ds_read_b64_tr_b16 v[40:41], v15 offset:24576
ds_read_b64_tr_b16 v[42:43], v15 offset:25600
s_lshl_b32 s55, s55, 8
s_bfe_u32 s45, s2, 0x10003
s_waitcnt vmcnt(11)
ds_read_b64_tr_b16 a[16:17], v118 offset:4096
ds_read_b64_tr_b16 a[18:19], v118 offset:5120
v_mfma_f32_32x32x16_bf16 v[224:239], v[64:67], v[44:47], v[224:239]
s_lshl_b32 s45, s45, 6
ds_read_b64_tr_b16 a[20:21], v119 offset:4096
ds_read_b64_tr_b16 a[22:23], v119 offset:5120
v_mfma_f32_32x32x16_bf16 v[176:191], v[56:59], v[48:51], v[176:191]
s_add_u32 s55, s55, s45
s_add_u32 s55, s55, 65536
ds_read_b64_tr_b16 a[24:25], v118 offset:6144
ds_read_b64_tr_b16 a[26:27], v118 offset:7168
v_mfma_f32_32x32x16_bf16 v[240:255], v[64:67], v[48:51], v[240:255]
buffer_load_dword v127, v126, s[16:19], s55 offen sc1
ds_read_b64_tr_b16 a[28:29], v119 offset:6144
ds_read_b64_tr_b16 a[30:31], v119 offset:7168
s_waitcnt lgkmcnt(8)
v_mfma_f32_32x32x16_bf16 v[128:143], v[28:31], v[20:23], v[128:143]
ds_read_b128 v[44:47], v13 offset:0
ds_read_b128 v[48:51], v13 offset:4096
s_waitcnt lgkmcnt(15)
v_mfma_f32_32x32x16_bf16 v[192:207], v[36:39], v[20:23], v[192:207]
ds_read_b64_tr_b16 v[52:53], v14 offset:12288
ds_read_b64_tr_b16 v[54:55], v14 offset:13312
s_add_u32 m0, s33, 0
s_mov_b32 s48, s28
s_add_u32 s28, s28, 14336
s_cmp_eq_u32 s28, s29
s_cselect_b32 s28, s42, s28
buffer_load_dwordx4 v120, s[56:59], s48 offen lds
v_mfma_f32_32x32x16_bf16 v[144:159], v[28:31], v[24:27], v[144:159]
ds_read_b64_tr_b16 v[56:57], v15 offset:12288
ds_read_b64_tr_b16 v[58:59], v15 offset:13312
v_mfma_f32_32x32x16_bf16 v[208:223], v[36:39], v[24:27], v[208:223]
ds_read_b64_tr_b16 v[60:61], v14 offset:28672
ds_read_b64_tr_b16 v[62:63], v14 offset:29696
s_add_u32 m0, s33, 0
s_nop 0
buffer_load_dwordx4 v121, s[56:59], s48 offen offset:1024 lds
v_mfma_f32_32x32x16_bf16 v[160:175], v[32:35], v[20:23], v[160:175]
ds_read_b64_tr_b16 v[64:65], v15 offset:28672
ds_read_b64_tr_b16 v[66:67], v15 offset:29696
s_add_u32 m0, s33, 2048
s_mov_b32 s48, s28
s_add_u32 s28, s28, 14336
s_cmp_eq_u32 s28, s29
s_cselect_b32 s28, s42, s28
buffer_load_dwordx4 v120, s[56:59], s48 offen lds
v_mfma_f32_32x32x16_bf16 v[224:239], v[40:43], v[20:23], v[224:239]
v_mfma_f32_32x32x16_bf16 v[176:191], v[32:35], v[24:27], v[176:191]
s_add_u32 m0, s33, 2048
s_nop 0
buffer_load_dwordx4 v121, s[56:59], s48 offen offset:1024 lds
v_mfma_f32_32x32x16_bf16 v[240:255], v[40:43], v[24:27], v[240:255]
s_waitcnt lgkmcnt(0)
v_mfma_f32_32x32x16_bf16 v[128:143], v[52:55], v[44:47], v[128:143]
s_waitcnt lgkmcnt(10)
v_mfma_f32_32x32x16_bf16 v[192:207], v[60:63], v[44:47], v[192:207]
s_add_u32 m0, s33, 4096
s_mov_b32 s48, s28
s_add_u32 s28, s28, 14336
s_cmp_eq_u32 s28, s29
s_cselect_b32 s28, s42, s28
buffer_load_dwordx4 v120, s[56:59], s48 offen lds
v_mfma_f32_32x32x16_bf16 v[144:159], v[52:55], v[48:51], v[144:159]
v_mfma_f32_32x32x16_bf16 v[208:223], v[60:63], v[48:51], v[208:223]
s_add_u32 m0, s33, 4096
s_nop 0
buffer_load_dwordx4 v121, s[56:59], s48 offen offset:1024 lds
v_mfma_f32_32x32x16_bf16 v[160:175], v[56:59], v[44:47], v[160:175]
s_add_u32 m0, s33, 6144
s_mov_b32 s48, s28
s_add_u32 s28, s28, 14336
s_cmp_eq_u32 s28, s29
s_cselect_b32 s28, s42, s28
buffer_load_dwordx4 v120, s[56:59], s48 offen lds
s_waitcnt vmcnt(10)
v_and_b32 v108, 31, v1
s_lshl_b32 s46, s40, 9
s_add_u32 s46, s46, 18432
v_mfma_f32_32x32x16_bf16 v[224:239], v[64:67], v[44:47], v[224:239]
v_lshl_add_u32 v108, v108, 3, s46
v_lshrrev_b32 v109, 5, v1
s_lshl_b32 s46, s39, 8
s_add_u32 s46, s46, 19456
v_mfma_f32_32x32x16_bf16 v[176:191], v[56:59], v[48:51], v[176:191]
s_add_u32 m0, s33, 6144
s_nop 0
buffer_load_dwordx4 v121, s[56:59], s48 offen offset:1024 lds
v_lshl_add_u32 v109, v109, 4, s46
ds_read_b64 v[110:111], v108
ds_read_b64 v[112:113], v108 offset:256
ds_read_b128 v[72:75], v109
v_mfma_f32_32x32x16_bf16 v[240:255], v[64:67], v[48:51], v[240:255]
ds_read_b128 v[76:79], v109 offset:32
ds_read_b128 v[80:83], v109 offset:512
ds_read_b128 v[84:87], v109 offset:544
v_add_u32 v109, 64, v109
s_waitcnt lgkmcnt(0)
s_barrier
        v_rcp_f32 v114, v111
        v_sub_f32 v100, 0, v110
        v_mul_f32 v101, v111, v111
        v_mul_f32 v102, 0xc0135761, v114
        v_mul_f32 v115, v114, v114
        v_mul_f32 v115, v115, v114
        v_mul_f32 v103, 0xbdd2d3e8, v115

        v_rcp_f32 v114, v113
        v_sub_f32 v104, 0, v112
        v_mul_f32 v105, v113, v113
        v_mul_f32 v106, 0xc0135761, v114
        v_mul_f32 v115, v114, v114
        v_mul_f32 v115, v115, v114
        v_mul_f32 v107, 0xbdd2d3e8, v115

s_mov_b32 s45, 0
s_mov_b32 s46, s49
s_mov_b32 s96, s43
s_mov_b32 m0, s96
s_add_u32 s96, s96, 2048
s_mov_b32 s48, s28
s_add_u32 s28, s28, 14336
s_cmp_eq_u32 s28, s29
s_cselect_b32 s28, s42, s28
buffer_load_dwordx4 v120, s[56:59], s48 offen lds
buffer_load_dwordx4 v121, s[56:59], s48 offen offset:1024 lds
E1_loop:
s_set_gpr_idx_on s45, gpr_idx(SRC2)
v_pk_fma_f32 v[20:21], v[72:73], v[100:101], v[128:129] op_sel_hi:[1,0,1]
v_pk_fma_f32 v[28:29], v[80:81], v[100:101], v[192:193] op_sel_hi:[1,0,1]
v_pk_fma_f32 v[22:23], v[74:75], v[100:101], v[130:131] op_sel_hi:[1,0,1]
v_pk_fma_f32 v[30:31], v[82:83], v[100:101], v[194:195] op_sel_hi:[1,0,1]
v_pk_fma_f32 v[24:25], v[76:77], v[100:101], v[132:133] op_sel_hi:[1,0,1]
v_pk_fma_f32 v[32:33], v[84:85], v[100:101], v[196:197] op_sel_hi:[1,0,1]
v_pk_fma_f32 v[26:27], v[78:79], v[100:101], v[134:135] op_sel_hi:[1,0,1]
v_pk_fma_f32 v[34:35], v[86:87], v[100:101], v[198:199] op_sel_hi:[1,0,1]
v_pk_fma_f32 v[44:45], v[72:73], v[104:105], v[144:145] op_sel_hi:[1,0,1]
v_pk_fma_f32 v[52:53], v[80:81], v[104:105], v[208:209] op_sel_hi:[1,0,1]
v_pk_fma_f32 v[46:47], v[74:75], v[104:105], v[146:147] op_sel_hi:[1,0,1]
v_pk_fma_f32 v[54:55], v[82:83], v[104:105], v[210:211] op_sel_hi:[1,0,1]
v_pk_fma_f32 v[48:49], v[76:77], v[104:105], v[148:149] op_sel_hi:[1,0,1]
v_pk_fma_f32 v[56:57], v[84:85], v[104:105], v[212:213] op_sel_hi:[1,0,1]
v_pk_fma_f32 v[50:51], v[78:79], v[104:105], v[150:151] op_sel_hi:[1,0,1]
v_pk_fma_f32 v[58:59], v[86:87], v[104:105], v[214:215] op_sel_hi:[1,0,1]
s_set_gpr_idx_off
ds_read_b128 v[72:75], v109
ds_read_b128 v[76:79], v109 offset:32
ds_read_b128 v[80:83], v109 offset:512
ds_read_b128 v[84:87], v109 offset:544
v_add_u32 v109, 64, v109
s_mov_b32 m0, s96
s_add_u32 s96, s96, 2048
s_mov_b32 s48, s28
s_add_u32 s28, s28, 14336
s_cmp_eq_u32 s28, s29
s_cselect_b32 s28, s42, s28
buffer_load_dwordx4 v120, s[56:59], s48 offen lds
buffer_load_dwordx4 v121, s[56:59], s48 offen offset:1024 lds
v_pk_mul_f32 v[36:37], v[20:21], v[20:21]
v_pk_mul_f32 v[38:39], v[22:23], v[22:23]
v_pk_mul_f32 v[40:41], v[24:25], v[24:25]
v_pk_mul_f32 v[42:43], v[26:27], v[26:27]
v_pk_fma_f32 v[36:37], v[36:37], v[102:103], v[102:103] op_sel:[0,1,0] op_sel_hi:[1,1,0]
v_pk_fma_f32 v[38:39], v[38:39], v[102:103], v[102:103] op_sel:[0,1,0] op_sel_hi:[1,1,0]
v_pk_fma_f32 v[40:41], v[40:41], v[102:103], v[102:103] op_sel:[0,1,0] op_sel_hi:[1,1,0]
v_pk_fma_f32 v[42:43], v[42:43], v[102:103], v[102:103] op_sel:[0,1,0] op_sel_hi:[1,1,0]
v_pk_mul_f32 v[36:37], v[36:37], v[20:21]
v_pk_mul_f32 v[38:39], v[38:39], v[22:23]
v_pk_mul_f32 v[40:41], v[40:41], v[24:25]
v_pk_mul_f32 v[42:43], v[42:43], v[26:27]
v_exp_f32 v36, v36
v_exp_f32 v37, v37
v_exp_f32 v38, v38
v_exp_f32 v39, v39
v_exp_f32 v40, v40
v_exp_f32 v41, v41
v_exp_f32 v42, v42
v_exp_f32 v43, v43
v_pk_mul_f32 v[28:29], v[28:29], v[20:21]
v_pk_mul_f32 v[30:31], v[30:31], v[22:23]
v_pk_mul_f32 v[32:33], v[32:33], v[24:25]
v_pk_mul_f32 v[34:35], v[34:35], v[26:27]
v_pk_fma_f32 v[36:37], v[36:37], v[100:101], v[100:101] op_sel:[0,1,1] op_sel_hi:[1,1,1]
v_pk_fma_f32 v[38:39], v[38:39], v[100:101], v[100:101] op_sel:[0,1,1] op_sel_hi:[1,1,1]
v_pk_fma_f32 v[40:41], v[40:41], v[100:101], v[100:101] op_sel:[0,1,1] op_sel_hi:[1,1,1]
v_pk_fma_f32 v[42:43], v[42:43], v[100:101], v[100:101] op_sel:[0,1,1] op_sel_hi:[1,1,1]
v_rcp_f32 v36, v36
v_rcp_f32 v37, v37
v_rcp_f32 v38, v38
v_rcp_f32 v39, v39
v_rcp_f32 v40, v40
v_rcp_f32 v41, v41
v_rcp_f32 v42, v42
v_rcp_f32 v43, v43
v_pk_mul_f32 v[28:29], v[28:29], v[36:37]
v_pk_mul_f32 v[30:31], v[30:31], v[38:39]
v_pk_mul_f32 v[32:33], v[32:33], v[40:41]
v_pk_mul_f32 v[34:35], v[34:35], v[42:43]
v_cvt_pk_bf16_f32 v88, v28, v29
v_cvt_pk_bf16_f32 v89, v30, v31
v_cvt_pk_bf16_f32 v90, v32, v33
v_cvt_pk_bf16_f32 v91, v34, v35
buffer_store_dwordx4 v[88:91], v18, s[16:19], s46 offen sc1
s_mov_b32 m0, s96
s_add_u32 s96, s96, 2048
s_mov_b32 s48, s28
s_add_u32 s28, s28, 14336
s_cmp_eq_u32 s28, s29
s_cselect_b32 s28, s42, s28
buffer_load_dwordx4 v120, s[56:59], s48 offen lds
buffer_load_dwordx4 v121, s[56:59], s48 offen offset:1024 lds
v_pk_mul_f32 v[60:61], v[44:45], v[44:45]
v_pk_mul_f32 v[62:63], v[46:47], v[46:47]
v_pk_mul_f32 v[64:65], v[48:49], v[48:49]
v_pk_mul_f32 v[66:67], v[50:51], v[50:51]
v_pk_fma_f32 v[60:61], v[60:61], v[106:107], v[106:107] op_sel:[0,1,0] op_sel_hi:[1,1,0]
v_pk_fma_f32 v[62:63], v[62:63], v[106:107], v[106:107] op_sel:[0,1,0] op_sel_hi:[1,1,0]
v_pk_fma_f32 v[64:65], v[64:65], v[106:107], v[106:107] op_sel:[0,1,0] op_sel_hi:[1,1,0]
v_pk_fma_f32 v[66:67], v[66:67], v[106:107], v[106:107] op_sel:[0,1,0] op_sel_hi:[1,1,0]
v_pk_mul_f32 v[60:61], v[60:61], v[44:45]
v_pk_mul_f32 v[62:63], v[62:63], v[46:47]
v_pk_mul_f32 v[64:65], v[64:65], v[48:49]
v_pk_mul_f32 v[66:67], v[66:67], v[50:51]
v_exp_f32 v60, v60
v_exp_f32 v61, v61
v_exp_f32 v62, v62
v_exp_f32 v63, v63
v_exp_f32 v64, v64
v_exp_f32 v65, v65
v_exp_f32 v66, v66
v_exp_f32 v67, v67
v_pk_mul_f32 v[52:53], v[52:53], v[44:45]
v_pk_mul_f32 v[54:55], v[54:55], v[46:47]
v_pk_mul_f32 v[56:57], v[56:57], v[48:49]
v_pk_mul_f32 v[58:59], v[58:59], v[50:51]
v_pk_fma_f32 v[60:61], v[60:61], v[104:105], v[104:105] op_sel:[0,1,1] op_sel_hi:[1,1,1]
v_pk_fma_f32 v[62:63], v[62:63], v[104:105], v[104:105] op_sel:[0,1,1] op_sel_hi:[1,1,1]
v_pk_fma_f32 v[64:65], v[64:65], v[104:105], v[104:105] op_sel:[0,1,1] op_sel_hi:[1,1,1]
v_pk_fma_f32 v[66:67], v[66:67], v[104:105], v[104:105] op_sel:[0,1,1] op_sel_hi:[1,1,1]
v_rcp_f32 v60, v60
v_rcp_f32 v61, v61
v_rcp_f32 v62, v62
v_rcp_f32 v63, v63
v_rcp_f32 v64, v64
v_rcp_f32 v65, v65
v_rcp_f32 v66, v66
v_rcp_f32 v67, v67
v_pk_mul_f32 v[52:53], v[52:53], v[60:61]
v_pk_mul_f32 v[54:55], v[54:55], v[62:63]
v_pk_mul_f32 v[56:57], v[56:57], v[64:65]
v_pk_mul_f32 v[58:59], v[58:59], v[66:67]
v_cvt_pk_bf16_f32 v92, v52, v53
v_cvt_pk_bf16_f32 v93, v54, v55
v_cvt_pk_bf16_f32 v94, v56, v57
v_cvt_pk_bf16_f32 v95, v58, v59
s_add_u32 s47, s46, 114688
buffer_store_dwordx4 v[92:95], v18, s[16:19], s47 offen sc1
s_cmp_eq_u32 s45, 0
s_cbranch_scc1 E1_b0
s_cmp_eq_u32 s45, 8
s_cbranch_scc1 E1_b1
s_cmp_eq_u32 s45, 32
s_cbranch_scc1 E1_b2
s_branch E1_b3
E1_b0:
s_waitcnt vmcnt(16)
v_cmp_ne_u32 vcc, s50, v127
s_cbranch_vccz G_pk_done
    s_mov_b32 s51, 0x8000
    G_pk_loop:
    buffer_load_dword v127, v126, s[16:19], s55 offen sc1
    s_waitcnt vmcnt(0)
    v_cmp_ne_u32 vcc, s50, v127
    s_cbranch_vccz G_pk_done
    s_sleep 1
    s_sub_u32 s51, s51, 1
    s_cmp_lg_u32 s51, 0
    s_cbranch_scc1 G_pk_loop
    G_pk_done:

s_lshl_b32 s98, s2, 13
s_add_u32 s98, s98, s3
s_add_u32 s98, s98, 327680
s_mul_i32 s47, s40, 5120
s_lshl_b32 s99, s39, 11
s_add_u32 s47, s47, s99
s_add_u32 m0, s47, 152576
s_nop 0
buffer_load_dwordx4 v18, s[16:19], s98 offen sc1 lds
buffer_load_dwordx4 v18, s[16:19], s98 offen offset:1024 sc1 lds
s_waitcnt vmcnt(25)
v_lshlrev_b32 v16, 4, v0
v_add_u32 v16, 114720, v16
v_accvgpr_read_b32 v2, a224
v_accvgpr_read_b32 v3, a225
v_accvgpr_read_b32 v4, a226
v_accvgpr_read_b32 v5, a227
v_accvgpr_read_b32 v6, a228
v_accvgpr_read_b32 v7, a229
v_alignbit_b32 v8, v3, v2, 16
v_alignbit_b32 v9, v4, v3, 16
v_alignbit_b32 v10, v5, v4, 16
v_alignbit_b32 v11, v6, v5, 16
v_mov_b32 v12, v9
v_mov_b32 v13, v10
v_mov_b32 v14, v11
v_alignbit_b32 v15, v7, v6, 16
ds_write_b128 v16, v[8:11] offset:4160
ds_write_b128 v16, v[12:15] offset:12480
s_branch E1_next
E1_b1:
v_lshlrev_b32 v16, 4, v0
v_add_u32 v16, 131360, v16
v_accvgpr_read_b32 v2, a232
v_accvgpr_read_b32 v3, a233
v_accvgpr_read_b32 v4, a234
v_accvgpr_read_b32 v5, a235
v_accvgpr_read_b32 v6, a236
v_accvgpr_read_b32 v7, a237
v_alignbit_b32 v8, v3, v2, 16
v_alignbit_b32 v9, v4, v3, 16
v_alignbit_b32 v10, v5, v4, 16
v_alignbit_b32 v11, v6, v5, 16
v_mov_b32 v12, v9
v_mov_b32 v13, v10
v_mov_b32 v14, v11
v_alignbit_b32 v15, v7, v6, 16
ds_write_b128 v16, v[8:11] offset:4160
ds_write_b128 v16, v[12:15] offset:12480
s_waitcnt vmcnt(16)
ds_read_b64_tr_b16 a[32:33], v118 offset:0
ds_read_b64_tr_b16 a[34:35], v118 offset:1024
ds_read_b64_tr_b16 a[36:37], v119 offset:0
ds_read_b64_tr_b16 a[38:39], v119 offset:1024
ds_read_b64_tr_b16 a[40:41], v118 offset:2048
ds_read_b64_tr_b16 a[42:43], v118 offset:3072
ds_read_b64_tr_b16 a[44:45], v119 offset:2048
ds_read_b64_tr_b16 a[46:47], v119 offset:3072
ds_read_b64_tr_b16 a[48:49], v118 offset:4096
ds_read_b64_tr_b16 a[50:51], v118 offset:5120
ds_read_b64_tr_b16 a[52:53], v119 offset:4096
ds_read_b64_tr_b16 a[54:55], v119 offset:5120
ds_read_b64_tr_b16 a[56:57], v118 offset:6144
ds_read_b64_tr_b16 a[58:59], v118 offset:7168
ds_read_b64_tr_b16 a[60:61], v119 offset:6144
ds_read_b64_tr_b16 a[62:63], v119 offset:7168
s_branch E1_next
E1_b2:
    s_cmp_eq_u32 s36, 0
    s_cbranch_scc0 CB_w1
    v_mov_b32 v8, 0
    v_mov_b32 v9, 0
    v_mov_b32 v10, 0
    v_mov_b32 v11, 0

        v_accvgpr_read_b32 v12, a224
        v_accvgpr_read_b32 v13, a225
        s_nop 0
        v_readlane_b32 s34, v12, 0
        v_readlane_b32 s35, v13, 0
        s_nop 3
        s_lshl_b32 s98, s34, 16
        s_lshr_b32 s99, s34, 16
        s_lshl_b32 s35, s35, 16
        s_or_b32 s99, s99, s35
        v_writelane_b32 v11, s98, 3
        v_writelane_b32 v11, s34, 5
        v_writelane_b32 v11, s99, 7
        v_writelane_b32 v10, s98, 7

        v_accvgpr_read_b32 v12, a232
        v_accvgpr_read_b32 v13, a233
        s_nop 0
        v_readlane_b32 s34, v12, 0
        v_readlane_b32 s35, v13, 0
        s_nop 3
        s_lshl_b32 s98, s34, 16
        s_lshr_b32 s99, s34, 16
        s_lshl_b32 s35, s35, 16
        s_or_b32 s99, s99, s35
        v_writelane_b32 v11, s98, 11
        v_writelane_b32 v11, s34, 13
        v_writelane_b32 v11, s99, 15
        v_writelane_b32 v10, s98, 15

    v_lshrrev_b32 v12, 3, v1
    v_mul_u32_u24 v12, 16640, v12
    v_bfe_u32 v13, v1, 1, 2
    v_mul_u32_u24 v13, 4160, v13
    v_add_u32 v12, v12, v13
    v_and_b32 v13, 1, v1
    v_lshl_add_u32 v12, v13, 4, v12
    v_add_u32 v12, 114688, v12
    s_mov_b64 exec, 0xffff
    ds_write_b128 v12, v[8:11]
    s_mov_b64 exec, -1
    s_branch CB_done
    CB_w1:
    s_cmp_eq_u32 s36, 1
    s_cbranch_scc0 CB_done
    v_mov_b32 v8, 0
    v_mov_b32 v9, 0
    v_mov_b32 v10, 0
    v_mov_b32 v11, 0
    v_add_u32 v12, 156672, v18
    ds_write_b128 v12, v[8:11]
    ds_write_b128 v12, v[8:11] offset:5120
    CB_done:

s_branch E1_next
E1_b3:
s_add_u32 m0, s33, 0
s_mov_b32 s48, s28
s_add_u32 s28, s28, 14336
s_cmp_eq_u32 s28, s29
s_cselect_b32 s28, s42, s28
buffer_load_dwordx4 v120, s[56:59], s48 offen lds
s_add_u32 m0, s33, 0
s_nop 0
buffer_load_dwordx4 v121, s[56:59], s48 offen offset:1024 lds
s_add_u32 m0, s33, 2048
s_mov_b32 s48, s28
s_add_u32 s28, s28, 14336
s_cmp_eq_u32 s28, s29
s_cselect_b32 s28, s42, s28
buffer_load_dwordx4 v120, s[56:59], s48 offen lds
s_add_u32 m0, s33, 2048
s_nop 0
buffer_load_dwordx4 v121, s[56:59], s48 offen offset:1024 lds
s_add_u32 m0, s33, 4096
s_mov_b32 s48, s28
s_add_u32 s28, s28, 14336
s_cmp_eq_u32 s28, s29
s_cselect_b32 s28, s42, s28
buffer_load_dwordx4 v120, s[56:59], s48 offen lds
s_add_u32 m0, s33, 4096
s_nop 0
buffer_load_dwordx4 v121, s[56:59], s48 offen offset:1024 lds
s_add_u32 m0, s33, 6144
s_mov_b32 s48, s28
s_add_u32 s28, s28, 14336
s_cmp_eq_u32 s28, s29
s_cselect_b32 s28, s42, s28
buffer_load_dwordx4 v120, s[56:59], s48 offen lds
s_add_u32 m0, s33, 6144
s_nop 0
buffer_load_dwordx4 v121, s[56:59], s48 offen offset:1024 lds
E1_next:
    s_add_u32 s46, s46, 1024
    s_add_u32 s45, s45, 8
    s_bitcmp1_b32 s45, 4
    s_cselect_b32 s47, 16, 0
    s_add_u32 s45, s45, s47
    s_cmp_lt_u32 s45, 64
    s_waitcnt lgkmcnt(0)
    s_cbranch_scc1 E1_loop

s_waitcnt vmcnt(26)
s_waitcnt lgkmcnt(0)
s_barrier
ds_read_b64 v[160:161], v124 offset:0
ds_read_b64 v[162:163], v124 offset:8
ds_read_b128 v[192:195], v125 offset:3584
ds_read_b64 v[164:165], v124 offset:512
ds_read_b64 v[166:167], v124 offset:520
ds_read_b128 v[196:199], v125 offset:3072
ds_read_b64 v[168:169], v124 offset:1024
ds_read_b64 v[170:171], v124 offset:1032
ds_read_b128 v[200:203], v125 offset:2560
ds_read_b64 v[172:173], v124 offset:1536
ds_read_b64 v[174:175], v124 offset:1544
ds_read_b128 v[204:207], v125 offset:2048
ds_read_b64 v[176:177], v124 offset:2048
ds_read_b64 v[178:179], v124 offset:2056
ds_read_b128 v[208:211], v125 offset:1536
ds_read_b64 v[180:181], v124 offset:2560
ds_read_b64 v[182:183], v124 offset:2568
ds_read_b128 v[212:215], v125 offset:1024
ds_read_b64 v[184:185], v124 offset:3072
ds_read_b64 v[186:187], v124 offset:3080
ds_read_b128 v[216:219], v125 offset:512
ds_read_b64 v[188:189], v124 offset:3584
ds_read_b64 v[190:191], v124 offset:3592
ds_read_b128 v[220:223], v125 offset:0
s_waitcnt lgkmcnt(0)
v_mfma_f32_16x16x32_bf16 v[128:131], v[160:163], v[196:199], 0
ds_read_b64 v[20:21], v124 offset:64
ds_read_b64 v[22:23], v124 offset:72
s_waitcnt vmcnt(9)
ds_read_b64_tr_b16 a[64:65], v122 offset:0
v_mfma_f32_16x16x32_bf16 v[128:131], v[164:167], v[192:195], v[128:131]
ds_read_b128 v[56:59], v125 offset:3648
ds_read_b64_tr_b16 a[66:67], v122 offset:1024
v_mfma_f32_16x16x32_bf16 v[132:135], v[164:167], v[200:203], 0
ds_read_b64 v[24:25], v124 offset:576
ds_read_b64 v[26:27], v124 offset:584
ds_read_b64_tr_b16 a[68:69], v123 offset:0
v_mfma_f32_16x16x32_bf16 v[132:135], v[168:171], v[196:199], v[132:135]
ds_read_b128 v[60:63], v125 offset:3136
ds_read_b64_tr_b16 a[70:71], v123 offset:1024
v_mfma_f32_16x16x32_bf16 v[132:135], v[160:163], v[204:207], v[132:135]
ds_read_b64 v[28:29], v124 offset:1088
ds_read_b64 v[30:31], v124 offset:1096
v_mfma_f32_16x16x32_bf16 v[136:139], v[168:171], v[204:207], 0
ds_read_b128 v[64:67], v125 offset:2624
v_mfma_f32_16x16x32_bf16 v[132:135], v[172:175], v[192:195], v[132:135]
ds_read_b64 v[32:33], v124 offset:1600
ds_read_b64 v[34:35], v124 offset:1608
ds_read_b64_tr_b16 a[72:73], v122 offset:2048
v_mfma_f32_16x16x32_bf16 v[136:139], v[172:175], v[200:203], v[136:139]
ds_read_b128 v[68:71], v125 offset:2112
ds_read_b64_tr_b16 a[74:75], v122 offset:3072
v_mfma_f32_16x16x32_bf16 v[136:139], v[164:167], v[208:211], v[136:139]
ds_read_b64 v[36:37], v124 offset:2112
ds_read_b64 v[38:39], v124 offset:2120
ds_read_b64_tr_b16 a[76:77], v123 offset:2048
s_waitcnt lgkmcnt(11)
s_add_u32 m0, s43, 0
s_mov_b32 s48, s28
s_add_u32 s28, s28, 14336
s_cmp_eq_u32 s28, s29
s_cselect_b32 s28, s42, s28
v_mfma_f32_16x16x32_bf16 v[140:143], v[172:175], v[208:211], 0
ds_read_b128 v[72:75], v125 offset:1600
ds_read_b64_tr_b16 a[78:79], v123 offset:3072
buffer_load_dwordx4 v120, s[56:59], s48 offen lds
buffer_load_dwordx4 v121, s[56:59], s48 offen offset:1024 lds
v_mfma_f32_16x16x32_bf16 v[136:139], v[176:179], v[196:199], v[136:139]
ds_read_b64 v[40:41], v124 offset:2624
ds_read_b64 v[42:43], v124 offset:2632
v_mfma_f32_16x16x32_bf16 v[140:143], v[176:179], v[204:207], v[140:143]
ds_read_b128 v[76:79], v125 offset:1088
v_mfma_f32_16x16x32_bf16 v[136:139], v[160:163], v[212:215], v[136:139]
ds_read_b64 v[44:45], v124 offset:3136
ds_read_b64 v[46:47], v124 offset:3144
ds_read_b64_tr_b16 a[80:81], v122 offset:4096
s_waitcnt vmcnt(10)
s_lshl_b32 s32, s37, 4
s_add_u32 s32, s32, s38
s_lshl_b32 s32, s32, 2
s_add_u32 s32, s32, s36
s_lshl_b32 s32, s32, 6
s_add_u32 s32, s32, 131072
v_mov_b32 v52, 0
v_mov_b32 v53, s50
s_mov_b64 exec, 1
buffer_store_dword v53, v52, s[16:19], s32 offen sc1
s_mov_b64 exec, -1
v_mfma_f32_16x16x32_bf16 v[140:143], v[168:171], v[212:215], v[140:143]
ds_read_b128 v[80:83], v125 offset:576
ds_read_b64_tr_b16 a[82:83], v122 offset:5120
v_mfma_f32_16x16x32_bf16 v[136:139], v[180:183], v[192:195], v[136:139]
ds_read_b64 v[48:49], v124 offset:3648
ds_read_b64 v[50:51], v124 offset:3656
ds_read_b64_tr_b16 a[84:85], v123 offset:4096
s_waitcnt lgkmcnt(11)
s_add_u32 m0, s43, 2048
s_mov_b32 s48, s28
s_add_u32 s28, s28, 14336
s_cmp_eq_u32 s28, s29
s_cselect_b32 s28, s42, s28
v_mfma_f32_16x16x32_bf16 v[140:143], v[180:183], v[200:203], v[140:143]
ds_read_b128 v[84:87], v125 offset:64
ds_read_b64_tr_b16 a[86:87], v123 offset:5120
buffer_load_dwordx4 v120, s[56:59], s48 offen lds
buffer_load_dwordx4 v121, s[56:59], s48 offen offset:1024 lds
v_mfma_f32_16x16x32_bf16 v[140:143], v[164:167], v[216:219], v[140:143]
v_mfma_f32_16x16x32_bf16 v[140:143], v[184:187], v[196:199], v[140:143]
v_mfma_f32_16x16x32_bf16 v[140:143], v[160:163], v[220:223], v[140:143]
ds_read_b64_tr_b16 a[88:89], v122 offset:6144
v_mfma_f32_16x16x32_bf16 v[140:143], v[188:191], v[192:195], v[140:143]
ds_read_b64_tr_b16 a[90:91], v122 offset:7168
s_waitcnt lgkmcnt(3)
v_mfma_f32_16x16x32_bf16 v[128:131], v[20:23], v[60:63], v[128:131]
ds_read_b64 v[160:161], v124 offset:128
ds_read_b64 v[162:163], v124 offset:136
ds_read_b64_tr_b16 a[92:93], v123 offset:6144
s_waitcnt lgkmcnt(5)
s_add_u32 m0, s43, 4096
s_mov_b32 s48, s28
s_add_u32 s28, s28, 14336
s_cmp_eq_u32 s28, s29
s_cselect_b32 s28, s42, s28
v_mfma_f32_16x16x32_bf16 v[128:131], v[24:27], v[56:59], v[128:131]
ds_read_b128 v[192:195], v125 offset:3712
ds_read_b64_tr_b16 a[94:95], v123 offset:7168
buffer_load_dwordx4 v120, s[56:59], s48 offen lds
buffer_load_dwordx4 v121, s[56:59], s48 offen offset:1024 lds
v_mfma_f32_16x16x32_bf16 v[132:135], v[24:27], v[64:67], v[132:135]
ds_read_b64 v[164:165], v124 offset:640
ds_read_b64 v[166:167], v124 offset:648
v_mfma_f32_16x16x32_bf16 v[132:135], v[28:31], v[60:63], v[132:135]
ds_read_b128 v[196:199], v125 offset:3200
v_mfma_f32_16x16x32_bf16 v[132:135], v[20:23], v[68:71], v[132:135]
ds_read_b64 v[168:169], v124 offset:1152
ds_read_b64 v[170:171], v124 offset:1160
ds_read_b64_tr_b16 a[96:97], v122 offset:8192
v_mfma_f32_16x16x32_bf16 v[136:139], v[28:31], v[68:71], v[136:139]
ds_read_b128 v[200:203], v125 offset:2688
ds_read_b64_tr_b16 a[98:99], v122 offset:9216
v_mfma_f32_16x16x32_bf16 v[132:135], v[32:35], v[56:59], v[132:135]
ds_read_b64 v[172:173], v124 offset:1664
ds_read_b64 v[174:175], v124 offset:1672
ds_read_b64_tr_b16 a[100:101], v123 offset:8192
s_waitcnt lgkmcnt(11)
s_add_u32 m0, s43, 6144
s_mov_b32 s48, s28
s_add_u32 s28, s28, 14336
s_cmp_eq_u32 s28, s29
s_cselect_b32 s28, s42, s28
v_mfma_f32_16x16x32_bf16 v[136:139], v[32:35], v[64:67], v[136:139]
ds_read_b128 v[204:207], v125 offset:2176
ds_read_b64_tr_b16 a[102:103], v123 offset:9216
buffer_load_dwordx4 v120, s[56:59], s48 offen lds
buffer_load_dwordx4 v121, s[56:59], s48 offen offset:1024 lds
v_mfma_f32_16x16x32_bf16 v[136:139], v[24:27], v[72:75], v[136:139]
ds_read_b64 v[176:177], v124 offset:2176
ds_read_b64 v[178:179], v124 offset:2184
v_mfma_f32_16x16x32_bf16 v[140:143], v[32:35], v[72:75], v[140:143]
ds_read_b128 v[208:211], v125 offset:1664
v_mfma_f32_16x16x32_bf16 v[136:139], v[36:39], v[60:63], v[136:139]
ds_read_b64 v[180:181], v124 offset:2688
ds_read_b64 v[182:183], v124 offset:2696
ds_read_b64_tr_b16 a[104:105], v122 offset:10240
v_mfma_f32_16x16x32_bf16 v[140:143], v[36:39], v[68:71], v[140:143]
ds_read_b128 v[212:215], v125 offset:1152
ds_read_b64_tr_b16 a[106:107], v122 offset:11264
v_mfma_f32_16x16x32_bf16 v[136:139], v[20:23], v[76:79], v[136:139]
ds_read_b64 v[184:185], v124 offset:3200
ds_read_b64 v[186:187], v124 offset:3208
ds_read_b64_tr_b16 a[108:109], v123 offset:10240
s_waitcnt lgkmcnt(11)
s_add_u32 m0, s43, 8192
s_mov_b32 s48, s28
s_add_u32 s28, s28, 14336
s_cmp_eq_u32 s28, s29
s_cselect_b32 s28, s42, s28
v_mfma_f32_16x16x32_bf16 v[140:143], v[28:31], v[76:79], v[140:143]
ds_read_b128 v[216:219], v125 offset:640
ds_read_b64_tr_b16 a[110:111], v123 offset:11264
buffer_load_dwordx4 v120, s[56:59], s48 offen lds
buffer_load_dwordx4 v121, s[56:59], s48 offen offset:1024 lds
v_mfma_f32_16x16x32_bf16 v[136:139], v[40:43], v[56:59], v[136:139]
ds_read_b64 v[188:189], v124 offset:3712
ds_read_b64 v[190:191], v124 offset:3720
v_mfma_f32_16x16x32_bf16 v[140:143], v[40:43], v[64:67], v[140:143]
ds_read_b128 v[220:223], v125 offset:128
v_mfma_f32_16x16x32_bf16 v[140:143], v[24:27], v[80:83], v[140:143]
ds_read_b64_tr_b16 a[112:113], v122 offset:12288
v_mfma_f32_16x16x32_bf16 v[140:143], v[44:47], v[60:63], v[140:143]
ds_read_b64_tr_b16 a[114:115], v122 offset:13312
v_mfma_f32_16x16x32_bf16 v[140:143], v[20:23], v[84:87], v[140:143]
ds_read_b64_tr_b16 a[116:117], v123 offset:12288
s_waitcnt lgkmcnt(6)
s_add_u32 m0, s43, 10240
s_mov_b32 s48, s28
s_add_u32 s28, s28, 14336
s_cmp_eq_u32 s28, s29
s_cselect_b32 s28, s42, s28
v_mfma_f32_16x16x32_bf16 v[140:143], v[48:51], v[56:59], v[140:143]
ds_read_b64_tr_b16 a[118:119], v123 offset:13312
buffer_load_dwordx4 v120, s[56:59], s48 offen lds
buffer_load_dwordx4 v121, s[56:59], s48 offen offset:1024 lds
s_waitcnt lgkmcnt(4)
v_mfma_f32_16x16x32_bf16 v[128:131], v[160:163], v[196:199], v[128:131]
ds_read_b64 v[20:21], v124 offset:192
ds_read_b64 v[22:23], v124 offset:200
v_mfma_f32_16x16x32_bf16 v[128:131], v[164:167], v[192:195], v[128:131]
ds_read_b128 v[56:59], v125 offset:3776
v_mfma_f32_16x16x32_bf16 v[132:135], v[164:167], v[200:203], v[132:135]
ds_read_b64 v[24:25], v124 offset:704
ds_read_b64 v[26:27], v124 offset:712
ds_read_b64_tr_b16 a[120:121], v122 offset:14336
v_mfma_f32_16x16x32_bf16 v[132:135], v[168:171], v[196:199], v[132:135]
ds_read_b128 v[60:63], v125 offset:3264
ds_read_b64_tr_b16 a[122:123], v122 offset:15360
v_mfma_f32_16x16x32_bf16 v[132:135], v[160:163], v[204:207], v[132:135]
ds_read_b64 v[28:29], v124 offset:1216
ds_read_b64 v[30:31], v124 offset:1224
ds_read_b64_tr_b16 a[124:125], v123 offset:14336
s_waitcnt lgkmcnt(11)
s_add_u32 m0, s43, 12288
s_mov_b32 s48, s28
s_add_u32 s28, s28, 14336
s_cmp_eq_u32 s28, s29
s_cselect_b32 s28, s42, s28
v_mfma_f32_16x16x32_bf16 v[136:139], v[168:171], v[204:207], v[136:139]
ds_read_b128 v[64:67], v125 offset:2752
ds_read_b64_tr_b16 a[126:127], v123 offset:15360
buffer_load_dwordx4 v120, s[56:59], s48 offen lds
buffer_load_dwordx4 v121, s[56:59], s48 offen offset:1024 lds
v_mfma_f32_16x16x32_bf16 v[132:135], v[172:175], v[192:195], v[132:135]
ds_read_b64 v[32:33], v124 offset:1728
ds_read_b64 v[34:35], v124 offset:1736
v_mfma_f32_16x16x32_bf16 v[136:139], v[172:175], v[200:203], v[136:139]
ds_read_b128 v[68:71], v125 offset:2240
v_mfma_f32_16x16x32_bf16 v[136:139], v[164:167], v[208:211], v[136:139]
ds_read_b64 v[36:37], v124 offset:2240
ds_read_b64 v[38:39], v124 offset:2248
ds_read_b64_tr_b16 a[128:129], v122 offset:16384
v_mfma_f32_16x16x32_bf16 v[140:143], v[172:175], v[208:211], v[140:143]
ds_read_b128 v[72:75], v125 offset:1728
ds_read_b64_tr_b16 a[130:131], v122 offset:17408
v_mfma_f32_16x16x32_bf16 v[136:139], v[176:179], v[196:199], v[136:139]
ds_read_b64 v[40:41], v124 offset:2752
ds_read_b64 v[42:43], v124 offset:2760
ds_read_b64_tr_b16 a[132:133], v123 offset:16384
v_mfma_f32_16x16x32_bf16 v[140:143], v[176:179], v[204:207], v[140:143]
ds_read_b128 v[76:79], v125 offset:1216
ds_read_b64_tr_b16 a[134:135], v123 offset:17408
v_mfma_f32_16x16x32_bf16 v[136:139], v[160:163], v[212:215], v[136:139]
ds_read_b64 v[44:45], v124 offset:3264
ds_read_b64 v[46:47], v124 offset:3272
v_mfma_f32_16x16x32_bf16 v[140:143], v[168:171], v[212:215], v[140:143]
ds_read_b128 v[80:83], v125 offset:704
v_mfma_f32_16x16x32_bf16 v[136:139], v[180:183], v[192:195], v[136:139]
ds_read_b64 v[48:49], v124 offset:3776
ds_read_b64 v[50:51], v124 offset:3784
s_waitcnt vmcnt(15)
ds_read_b64_tr_b16 a[136:137], v118 offset:0
v_mfma_f32_16x16x32_bf16 v[140:143], v[180:183], v[200:203], v[140:143]
ds_read_b128 v[84:87], v125 offset:192
ds_read_b64_tr_b16 a[138:139], v118 offset:1024
v_mfma_f32_16x16x32_bf16 v[140:143], v[164:167], v[216:219], v[140:143]
ds_read_b64_tr_b16 a[140:141], v119 offset:0
v_mfma_f32_16x16x32_bf16 v[140:143], v[184:187], v[196:199], v[140:143]
ds_read_b64_tr_b16 a[142:143], v119 offset:1024
v_mfma_f32_16x16x32_bf16 v[140:143], v[160:163], v[220:223], v[140:143]
v_mfma_f32_16x16x32_bf16 v[140:143], v[188:191], v[192:195], v[140:143]
s_waitcnt lgkmcnt(3)
v_mfma_f32_16x16x32_bf16 v[128:131], v[20:23], v[60:63], v[128:131]
ds_read_b64 v[160:161], v124 offset:256
ds_read_b64 v[162:163], v124 offset:264
ds_read_b64_tr_b16 a[144:145], v118 offset:2048
v_mfma_f32_16x16x32_bf16 v[128:131], v[24:27], v[56:59], v[128:131]
ds_read_b128 v[192:195], v125 offset:3840
ds_read_b64_tr_b16 a[146:147], v118 offset:3072
v_mfma_f32_16x16x32_bf16 v[132:135], v[24:27], v[64:67], v[132:135]
ds_read_b64 v[164:165], v124 offset:768
ds_read_b64 v[166:167], v124 offset:776
ds_read_b64_tr_b16 a[148:149], v119 offset:2048
v_mfma_f32_16x16x32_bf16 v[132:135], v[28:31], v[60:63], v[132:135]
ds_read_b128 v[196:199], v125 offset:3328
ds_read_b64_tr_b16 a[150:151], v119 offset:3072
v_mfma_f32_16x16x32_bf16 v[132:135], v[20:23], v[68:71], v[132:135]
ds_read_b64 v[168:169], v124 offset:1280
ds_read_b64 v[170:171], v124 offset:1288
v_mfma_f32_16x16x32_bf16 v[136:139], v[28:31], v[68:71], v[136:139]
ds_read_b128 v[200:203], v125 offset:2816
v_mfma_f32_16x16x32_bf16 v[132:135], v[32:35], v[56:59], v[132:135]
ds_read_b64 v[172:173], v124 offset:1792
ds_read_b64 v[174:175], v124 offset:1800
ds_read_b64_tr_b16 a[152:153], v118 offset:4096
v_min_u32 v126, 27, v1
v_lshrrev_b32 v127, 1, v126
v_mfma_f32_16x16x32_bf16 v[136:139], v[32:35], v[64:67], v[136:139]
ds_read_b128 v[204:207], v125 offset:2304
ds_read_b64_tr_b16 a[154:155], v118 offset:5120
v_and_b32 v126, 1, v126
v_mfma_f32_16x16x32_bf16 v[136:139], v[24:27], v[72:75], v[136:139]
ds_read_b64 v[176:177], v124 offset:2304
ds_read_b64 v[178:179], v124 offset:2312
ds_read_b64_tr_b16 a[156:157], v119 offset:4096
v_lshl_add_u32 v126, v127, 2, v126
v_lshlrev_b32 v126, 6, v126
v_mfma_f32_16x16x32_bf16 v[140:143], v[32:35], v[72:75], v[140:143]
ds_read_b128 v[208:211], v125 offset:1792
ds_read_b64_tr_b16 a[158:159], v119 offset:5120
s_lshl_b32 s55, s37, 12
v_mfma_f32_16x16x32_bf16 v[136:139], v[36:39], v[60:63], v[136:139]
ds_read_b64 v[180:181], v124 offset:2816
ds_read_b64 v[182:183], v124 offset:2824
s_lshl_b32 s45, s52, 7
s_add_u32 s55, s55, s45
v_mfma_f32_16x16x32_bf16 v[140:143], v[36:39], v[68:71], v[140:143]
ds_read_b128 v[212:215], v125 offset:1280
s_add_u32 s55, s55, 131072
v_mfma_f32_16x16x32_bf16 v[136:139], v[20:23], v[76:79], v[136:139]
ds_read_b64 v[184:185], v124 offset:3328
ds_read_b64 v[186:187], v124 offset:3336
ds_read_b64_tr_b16 a[160:161], v118 offset:6144
s_lshl_b32 s45, s37, 2
s_lshl_b32 s46, s52, 1
v_mfma_f32_16x16x32_bf16 v[140:143], v[28:31], v[76:79], v[140:143]
ds_read_b128 v[216:219], v125 offset:768
ds_read_b64_tr_b16 a[162:163], v118 offset:7168
s_add_u32 s45, s45, s46
s_mul_i32 s45, s45, 112
v_mfma_f32_16x16x32_bf16 v[136:139], v[40:43], v[56:59], v[136:139]
ds_read_b64 v[188:189], v124 offset:3840
ds_read_b64 v[190:191], v124 offset:3848
ds_read_b64_tr_b16 a[164:165], v119 offset:6144
s_mul_i32 s46, s36, 28
s_add_u32 s45, s45, s46
v_mfma_f32_16x16x32_bf16 v[140:143], v[40:43], v[64:67], v[140:143]
ds_read_b128 v[220:223], v125 offset:256
ds_read_b64_tr_b16 a[166:167], v119 offset:7168
s_lshl_b32 s41, s45, 10
s_add_u32 s41, s41, 3997696
v_mfma_f32_16x16x32_bf16 v[140:143], v[24:27], v[80:83], v[140:143]
s_mul_i32 s45, s39, 114688
v_add_u32 v2, s45, v18
v_mfma_f32_16x16x32_bf16 v[140:143], v[44:47], v[60:63], v[140:143]
s_sub_u32 s45, 113664, s45
v_add_u32 v3, s45, v18
v_mfma_f32_16x16x32_bf16 v[140:143], v[20:23], v[84:87], v[140:143]
v_add_u32 v4, s43, v18
s_add_u32 s31, s41, 28672
v_mfma_f32_16x16x32_bf16 v[140:143], v[48:51], v[56:59], v[140:143]
s_mov_b32 s30, s41
s_waitcnt lgkmcnt(1)
v_mfma_f32_16x16x32_bf16 v[128:131], v[160:163], v[196:199], v[128:131]
ds_read_b64 v[20:21], v124 offset:320
ds_read_b64 v[22:23], v124 offset:328
s_waitcnt vmcnt(13)
ds_read_b64_tr_b16 a[168:169], v122 offset:0
ds_read_b64_tr_b16 a[170:171], v122 offset:1024
v_mfma_f32_16x16x32_bf16 v[128:131], v[164:167], v[192:195], v[128:131]
ds_read_b128 v[56:59], v125 offset:3904
ds_read_b64_tr_b16 a[172:173], v123 offset:0
ds_read_b64_tr_b16 a[174:175], v123 offset:1024
v_mfma_f32_16x16x32_bf16 v[132:135], v[164:167], v[200:203], v[132:135]
ds_read_b64 v[24:25], v124 offset:832
ds_read_b64 v[26:27], v124 offset:840
v_mfma_f32_16x16x32_bf16 v[132:135], v[168:171], v[196:199], v[132:135]
ds_read_b128 v[60:63], v125 offset:3392
s_waitcnt vmcnt(10)
ds_read_b64_tr_b16 a[176:177], v122 offset:2048
ds_read_b64_tr_b16 a[178:179], v122 offset:3072
v_mfma_f32_16x16x32_bf16 v[132:135], v[160:163], v[204:207], v[132:135]
ds_read_b64 v[28:29], v124 offset:1344
ds_read_b64 v[30:31], v124 offset:1352
ds_read_b64_tr_b16 a[180:181], v123 offset:2048
ds_read_b64_tr_b16 a[182:183], v123 offset:3072
v_mfma_f32_16x16x32_bf16 v[136:139], v[168:171], v[204:207], v[136:139]
ds_read_b128 v[64:67], v125 offset:2880
v_mfma_f32_16x16x32_bf16 v[132:135], v[172:175], v[192:195], v[132:135]
ds_read_b64 v[32:33], v124 offset:1856
ds_read_b64 v[34:35], v124 offset:1864
s_waitcnt vmcnt(8)
ds_read_b64_tr_b16 a[184:185], v122 offset:4096
ds_read_b64_tr_b16 a[186:187], v122 offset:5120
v_mfma_f32_16x16x32_bf16 v[136:139], v[172:175], v[200:203], v[136:139]
ds_read_b128 v[68:71], v125 offset:2368
ds_read_b64_tr_b16 a[188:189], v123 offset:4096
ds_read_b64_tr_b16 a[190:191], v123 offset:5120
v_mfma_f32_16x16x32_bf16 v[136:139], v[164:167], v[208:211], v[136:139]
ds_read_b64 v[36:37], v124 offset:2368
ds_read_b64 v[38:39], v124 offset:2376
v_mfma_f32_16x16x32_bf16 v[140:143], v[172:175], v[208:211], v[140:143]
ds_read_b128 v[72:75], v125 offset:1856
s_waitcnt vmcnt(6)
ds_read_b64_tr_b16 a[192:193], v122 offset:6144
ds_read_b64_tr_b16 a[194:195], v122 offset:7168
v_mfma_f32_16x16x32_bf16 v[136:139], v[176:179], v[196:199], v[136:139]
ds_read_b64 v[40:41], v124 offset:2880
ds_read_b64 v[42:43], v124 offset:2888
ds_read_b64_tr_b16 a[196:197], v123 offset:6144
ds_read_b64_tr_b16 a[198:199], v123 offset:7168
buffer_load_dword v127, v126, s[16:19], s55 offen sc1
v_mfma_f32_16x16x32_bf16 v[140:143], v[176:179], v[204:207], v[140:143]
ds_read_b128 v[76:79], v125 offset:1344
v_mfma_f32_16x16x32_bf16 v[136:139], v[160:163], v[212:215], v[136:139]
ds_read_b64 v[44:45], v124 offset:3392
ds_read_b64 v[46:47], v124 offset:3400
s_waitcnt vmcnt(5)
ds_read_b64_tr_b16 a[200:201], v122 offset:8192
ds_read_b64_tr_b16 a[202:203], v122 offset:9216
v_mfma_f32_16x16x32_bf16 v[140:143], v[168:171], v[212:215], v[140:143]
ds_read_b128 v[80:83], v125 offset:832
ds_read_b64_tr_b16 a[204:205], v123 offset:8192
ds_read_b64_tr_b16 a[206:207], v123 offset:9216
v_mfma_f32_16x16x32_bf16 v[136:139], v[180:183], v[192:195], v[136:139]
ds_read_b64 v[48:49], v124 offset:3904
ds_read_b64 v[50:51], v124 offset:3912
v_mfma_f32_16x16x32_bf16 v[140:143], v[180:183], v[200:203], v[140:143]
ds_read_b128 v[84:87], v125 offset:320
s_waitcnt vmcnt(3)
ds_read_b64_tr_b16 a[208:209], v122 offset:10240
ds_read_b64_tr_b16 a[210:211], v122 offset:11264
v_mfma_f32_16x16x32_bf16 v[140:143], v[164:167], v[216:219], v[140:143]
ds_read_b64_tr_b16 a[212:213], v123 offset:10240
ds_read_b64_tr_b16 a[214:215], v123 offset:11264
v_mfma_f32_16x16x32_bf16 v[140:143], v[184:187], v[196:199], v[140:143]
v_mfma_f32_16x16x32_bf16 v[140:143], v[160:163], v[220:223], v[140:143]
s_waitcnt vmcnt(1)
ds_read_b64_tr_b16 a[216:217], v122 offset:12288
ds_read_b64_tr_b16 a[218:219], v122 offset:13312
v_mfma_f32_16x16x32_bf16 v[140:143], v[188:191], v[192:195], v[140:143]
ds_read_b64_tr_b16 a[220:221], v123 offset:12288
ds_read_b64_tr_b16 a[222:223], v123 offset:13312
s_waitcnt lgkmcnt(8)
v_mfma_f32_16x16x32_bf16 v[128:131], v[20:23], v[60:63], v[128:131]
ds_read_b64 v[160:161], v124 offset:384
ds_read_b64 v[162:163], v124 offset:392
v_mfma_f32_16x16x32_bf16 v[128:131], v[24:27], v[56:59], v[128:131]
ds_read_b128 v[192:195], v125 offset:3968
v_mfma_f32_16x16x32_bf16 v[132:135], v[24:27], v[64:67], v[132:135]
ds_read_b64 v[164:165], v124 offset:896
ds_read_b64 v[166:167], v124 offset:904
v_mfma_f32_16x16x32_bf16 v[132:135], v[28:31], v[60:63], v[132:135]
ds_read_b128 v[196:199], v125 offset:3456
v_mfma_f32_16x16x32_bf16 v[132:135], v[20:23], v[68:71], v[132:135]
ds_read_b64 v[168:169], v124 offset:1408
ds_read_b64 v[170:171], v124 offset:1416
s_waitcnt vmcnt(0)
v_cmp_ne_u32 vcc, s50, v127
s_cbranch_vccz G_p2_done
    s_mov_b32 s51, 0x8000
    G_p2_loop:
    buffer_load_dword v127, v126, s[16:19], s55 offen sc1
    s_waitcnt vmcnt(0)
    v_cmp_ne_u32 vcc, s50, v127
    s_cbranch_vccz G_p2_done
    s_sleep 1
    s_sub_u32 s51, s51, 1
    s_cmp_lg_u32 s51, 0
    s_cbranch_scc1 G_p2_loop
    G_p2_done:

s_waitcnt lgkmcnt(8)
v_mfma_f32_16x16x32_bf16 v[136:139], v[28:31], v[68:71], v[136:139]
ds_read_b128 v[200:203], v125 offset:2944
s_add_u32 m0, s43, 0
s_mov_b32 s48, s30
s_add_u32 s30, s30, 1024
s_cmp_eq_u32 s30, s31
s_cselect_b32 s30, s41, s30
buffer_load_dwordx4 v2, s[16:19], s48 offen sc1 lds
v_mfma_f32_16x16x32_bf16 v[132:135], v[32:35], v[56:59], v[132:135]
ds_read_b64 v[172:173], v124 offset:1920
ds_read_b64 v[174:175], v124 offset:1928
v_mfma_f32_16x16x32_bf16 v[136:139], v[32:35], v[64:67], v[136:139]
ds_read_b128 v[204:207], v125 offset:2432
s_add_u32 m0, s43, 0
s_nop 0
buffer_load_dwordx4 v3, s[16:19], s48 offen offset:1024 sc1 lds
v_mfma_f32_16x16x32_bf16 v[136:139], v[24:27], v[72:75], v[136:139]
ds_read_b64 v[176:177], v124 offset:2432
ds_read_b64 v[178:179], v124 offset:2440
v_mfma_f32_16x16x32_bf16 v[140:143], v[32:35], v[72:75], v[140:143]
ds_read_b128 v[208:211], v125 offset:1920
v_mfma_f32_16x16x32_bf16 v[136:139], v[36:39], v[60:63], v[136:139]
ds_read_b64 v[180:181], v124 offset:2944
ds_read_b64 v[182:183], v124 offset:2952
s_add_u32 m0, s43, 2048
s_mov_b32 s48, s30
s_add_u32 s30, s30, 1024
s_cmp_eq_u32 s30, s31
s_cselect_b32 s30, s41, s30
buffer_load_dwordx4 v2, s[16:19], s48 offen sc1 lds
v_mfma_f32_16x16x32_bf16 v[140:143], v[36:39], v[68:71], v[140:143]
ds_read_b128 v[212:215], v125 offset:1408
v_mfma_f32_16x16x32_bf16 v[136:139], v[20:23], v[76:79], v[136:139]
ds_read_b64 v[184:185], v124 offset:3456
ds_read_b64 v[186:187], v124 offset:3464
s_add_u32 m0, s43, 2048
s_nop 0
buffer_load_dwordx4 v3, s[16:19], s48 offen offset:1024 sc1 lds
v_mfma_f32_16x16x32_bf16 v[140:143], v[28:31], v[76:79], v[140:143]
ds_read_b128 v[216:219], v125 offset:896
v_mfma_f32_16x16x32_bf16 v[136:139], v[40:43], v[56:59], v[136:139]
ds_read_b64 v[188:189], v124 offset:3968
ds_read_b64 v[190:191], v124 offset:3976
v_mfma_f32_16x16x32_bf16 v[140:143], v[40:43], v[64:67], v[140:143]
ds_read_b128 v[220:223], v125 offset:384
s_add_u32 m0, s43, 4096
s_mov_b32 s48, s30
s_add_u32 s30, s30, 1024
s_cmp_eq_u32 s30, s31
s_cselect_b32 s30, s41, s30
buffer_load_dwordx4 v2, s[16:19], s48 offen sc1 lds
v_mfma_f32_16x16x32_bf16 v[140:143], v[24:27], v[80:83], v[140:143]
v_mfma_f32_16x16x32_bf16 v[140:143], v[44:47], v[60:63], v[140:143]
s_add_u32 m0, s43, 4096
s_nop 0
buffer_load_dwordx4 v3, s[16:19], s48 offen offset:1024 sc1 lds
v_mfma_f32_16x16x32_bf16 v[140:143], v[20:23], v[84:87], v[140:143]
v_mfma_f32_16x16x32_bf16 v[140:143], v[48:51], v[56:59], v[140:143]
s_waitcnt lgkmcnt(0)
v_mfma_f32_16x16x32_bf16 v[128:131], v[160:163], v[196:199], v[128:131]
ds_read_b64 v[20:21], v124 offset:448
ds_read_b64 v[22:23], v124 offset:456
s_add_u32 m0, s43, 6144
s_mov_b32 s48, s30
s_add_u32 s30, s30, 1024
s_cmp_eq_u32 s30, s31
s_cselect_b32 s30, s41, s30
buffer_load_dwordx4 v2, s[16:19], s48 offen sc1 lds
v_mfma_f32_16x16x32_bf16 v[128:131], v[164:167], v[192:195], v[128:131]
ds_read_b128 v[56:59], v125 offset:4032
v_mfma_f32_16x16x32_bf16 v[132:135], v[164:167], v[200:203], v[132:135]
ds_read_b64 v[24:25], v124 offset:960
ds_read_b64 v[26:27], v124 offset:968
s_add_u32 m0, s43, 6144
s_nop 0
buffer_load_dwordx4 v3, s[16:19], s48 offen offset:1024 sc1 lds
v_mfma_f32_16x16x32_bf16 v[132:135], v[168:171], v[196:199], v[132:135]
ds_read_b128 v[60:63], v125 offset:3520
v_mfma_f32_16x16x32_bf16 v[132:135], v[160:163], v[204:207], v[132:135]
ds_read_b64 v[28:29], v124 offset:1472
ds_read_b64 v[30:31], v124 offset:1480
v_mfma_f32_16x16x32_bf16 v[136:139], v[168:171], v[204:207], v[136:139]
ds_read_b128 v[64:67], v125 offset:3008
s_add_u32 m0, s43, 8192
s_mov_b32 s48, s30
s_add_u32 s30, s30, 1024
s_cmp_eq_u32 s30, s31
s_cselect_b32 s30, s41, s30
buffer_load_dwordx4 v2, s[16:19], s48 offen sc1 lds
v_mfma_f32_16x16x32_bf16 v[132:135], v[172:175], v[192:195], v[132:135]
ds_read_b64 v[32:33], v124 offset:1984
ds_read_b64 v[34:35], v124 offset:1992
v_mfma_f32_16x16x32_bf16 v[136:139], v[172:175], v[200:203], v[136:139]
ds_read_b128 v[68:71], v125 offset:2496
s_add_u32 m0, s43, 8192
s_nop 0
buffer_load_dwordx4 v3, s[16:19], s48 offen offset:1024 sc1 lds
v_mfma_f32_16x16x32_bf16 v[136:139], v[164:167], v[208:211], v[136:139]
ds_read_b64 v[36:37], v124 offset:2496
ds_read_b64 v[38:39], v124 offset:2504
v_mfma_f32_16x16x32_bf16 v[140:143], v[172:175], v[208:211], v[140:143]
ds_read_b128 v[72:75], v125 offset:1984
v_mfma_f32_16x16x32_bf16 v[136:139], v[176:179], v[196:199], v[136:139]
ds_read_b64 v[40:41], v124 offset:3008
ds_read_b64 v[42:43], v124 offset:3016
s_add_u32 m0, s43, 10240
s_mov_b32 s48, s30
s_add_u32 s30, s30, 1024
s_cmp_eq_u32 s30, s31
s_cselect_b32 s30, s41, s30
buffer_load_dwordx4 v2, s[16:19], s48 offen sc1 lds
v_mfma_f32_16x16x32_bf16 v[140:143], v[176:179], v[204:207], v[140:143]
ds_read_b128 v[76:79], v125 offset:1472
v_mfma_f32_16x16x32_bf16 v[136:139], v[160:163], v[212:215], v[136:139]
ds_read_b64 v[44:45], v124 offset:3520
ds_read_b64 v[46:47], v124 offset:3528
s_add_u32 m0, s43, 10240
s_nop 0
buffer_load_dwordx4 v3, s[16:19], s48 offen offset:1024 sc1 lds
v_mfma_f32_16x16x32_bf16 v[140:143], v[168:171], v[212:215], v[140:143]
ds_read_b128 v[80:83], v125 offset:960
v_mfma_f32_16x16x32_bf16 v[136:139], v[180:183], v[192:195], v[136:139]
ds_read_b64 v[48:49], v124 offset:4032
ds_read_b64 v[50:51], v124 offset:4040
v_mfma_f32_16x16x32_bf16 v[140:143], v[180:183], v[200:203], v[140:143]
ds_read_b128 v[84:87], v125 offset:448
s_add_u32 m0, s43, 12288
s_mov_b32 s48, s30
s_add_u32 s30, s30, 1024
s_cmp_eq_u32 s30, s31
s_cselect_b32 s30, s41, s30
buffer_load_dwordx4 v2, s[16:19], s48 offen sc1 lds
v_mfma_f32_16x16x32_bf16 v[140:143], v[164:167], v[216:219], v[140:143]
v_mfma_f32_16x16x32_bf16 v[140:143], v[184:187], v[196:199], v[140:143]
s_add_u32 m0, s43, 12288
s_nop 0
buffer_load_dwordx4 v3, s[16:19], s48 offen offset:1024 sc1 lds
v_mfma_f32_16x16x32_bf16 v[140:143], v[160:163], v[220:223], v[140:143]
v_mfma_f32_16x16x32_bf16 v[140:143], v[188:191], v[192:195], v[140:143]
v_and_b32 v54, 15, v1
v_lshrrev_b32 v55, 4, v1
s_waitcnt lgkmcnt(0)
v_mfma_f32_16x16x32_bf16 v[128:131], v[20:23], v[60:63], v[128:131]
s_add_u32 m0, s43, 14336
s_mov_b32 s48, s30
s_add_u32 s30, s30, 1024
s_cmp_eq_u32 s30, s31
s_cselect_b32 s30, s41, s30
buffer_load_dwordx4 v2, s[16:19], s48 offen sc1 lds
v_lshlrev_b32 v54, 5, v54
v_lshl_add_u32 v53, v55, 3, v54
v_mfma_f32_16x16x32_bf16 v[128:131], v[24:27], v[56:59], v[128:131]
s_mul_i32 s98, s40, 5120
v_mfma_f32_16x16x32_bf16 v[132:135], v[24:27], v[64:67], v[132:135]
s_add_u32 m0, s43, 14336
s_nop 0
buffer_load_dwordx4 v3, s[16:19], s48 offen offset:1024 sc1 lds
s_lshl_b32 s99, s39, 9
s_sub_u32 s98, s98, s99
v_mfma_f32_16x16x32_bf16 v[132:135], v[28:31], v[60:63], v[132:135]
s_add_u32 s98, s98, 153592
v_mfma_f32_16x16x32_bf16 v[132:135], v[20:23], v[68:71], v[132:135]
v_sub_u32 v52, s98, v53
s_lshl_b32 s98, s2, 13
v_mfma_f32_16x16x32_bf16 v[136:139], v[28:31], v[68:71], v[136:139]
s_add_u32 m0, s43, 16384
s_mov_b32 s48, s30
s_add_u32 s30, s30, 1024
s_cmp_eq_u32 s30, s31
s_cselect_b32 s30, s41, s30
buffer_load_dwordx4 v2, s[16:19], s48 offen sc1 lds
s_lshl_b32 s34, s40, 12
s_add_u32 s98, s98, s34
v_mfma_f32_16x16x32_bf16 v[132:135], v[32:35], v[56:59], v[132:135]
s_add_u32 s98, s98, s99
v_mfma_f32_16x16x32_bf16 v[136:139], v[32:35], v[64:67], v[136:139]
s_add_u32 m0, s43, 16384
s_nop 0
buffer_load_dwordx4 v3, s[16:19], s48 offen offset:1024 sc1 lds
s_add_u32 s98, s98, 2162688
s_cmp_eq_u32 s40, 0
s_cselect_b32 s99, s100, s101
v_mfma_f32_16x16x32_bf16 v[136:139], v[24:27], v[72:75], v[136:139]
ds_read_b64 v[88:89], v52 offset:3072
v_mfma_f32_16x16x32_bf16 v[140:143], v[32:35], v[72:75], v[140:143]
ds_read_b64 v[90:91], v52 offset:2048
ds_read_b64 v[92:93], v52 offset:1024
v_mfma_f32_16x16x32_bf16 v[136:139], v[36:39], v[60:63], v[136:139]
s_add_u32 m0, s43, 18432
s_mov_b32 s48, s30
s_add_u32 s30, s30, 1024
s_cmp_eq_u32 s30, s31
s_cselect_b32 s30, s41, s30
buffer_load_dwordx4 v2, s[16:19], s48 offen sc1 lds
ds_read_b64 v[94:95], v52 offset:0
v_mfma_f32_16x16x32_bf16 v[140:143], v[36:39], v[68:71], v[140:143]
v_mfma_f32_16x16x32_bf16 v[136:139], v[20:23], v[76:79], v[136:139]
s_add_u32 m0, s43, 18432
s_nop 0
buffer_load_dwordx4 v3, s[16:19], s48 offen offset:1024 sc1 lds
v_mfma_f32_16x16x32_bf16 v[140:143], v[28:31], v[76:79], v[140:143]
v_mfma_f32_16x16x32_bf16 v[136:139], v[40:43], v[56:59], v[136:139]
v_mfma_f32_16x16x32_bf16 v[140:143], v[40:43], v[64:67], v[140:143]
v_mfma_f32_16x16x32_bf16 v[140:143], v[24:27], v[80:83], v[140:143]
v_mfma_f32_16x16x32_bf16 v[140:143], v[44:47], v[60:63], v[140:143]
v_mfma_f32_16x16x32_bf16 v[140:143], v[20:23], v[84:87], v[140:143]
v_mfma_f32_16x16x32_bf16 v[140:143], v[48:51], v[56:59], v[140:143]
s_waitcnt lgkmcnt(0)
v_and_b32 v96, 0xffff0000, v89
v_lshlrev_b32 v97, 16, v89
v_and_b32 v98, 0xffff0000, v88
v_lshlrev_b32 v99, 16, v88
v_and_b32 v100, 0xffff0000, v91
v_lshlrev_b32 v101, 16, v91
v_and_b32 v102, 0xffff0000, v90
v_lshlrev_b32 v103, 16, v90
v_and_b32 v104, 0xffff0000, v93
v_lshlrev_b32 v105, 16, v93
v_and_b32 v106, 0xffff0000, v92
v_lshlrev_b32 v107, 16, v92
v_and_b32 v108, 0xffff0000, v95
v_lshlrev_b32 v109, 16, v95
v_and_b32 v110, 0xffff0000, v94
v_lshlrev_b32 v111, 16, v94
v_fmac_f32 v128, s99, v96
v_fmac_f32 v129, s99, v97
v_fmac_f32 v130, s99, v98
v_fmac_f32 v131, s99, v99
v_fmac_f32 v132, s99, v100
v_fmac_f32 v133, s99, v101
v_fmac_f32 v134, s99, v102
v_fmac_f32 v135, s99, v103
v_fmac_f32 v136, s99, v104
v_fmac_f32 v137, s99, v105
v_fmac_f32 v138, s99, v106
v_fmac_f32 v139, s99, v107
v_fmac_f32 v140, s99, v108
v_fmac_f32 v141, s99, v109
v_fmac_f32 v142, s99, v110
v_fmac_f32 v143, s99, v111
v_cvt_pk_bf16_f32 v112, v128, v129
v_cvt_pk_bf16_f32 v113, v130, v131
v_cvt_pk_bf16_f32 v114, v132, v133
v_cvt_pk_bf16_f32 v115, v134, v135
v_cvt_pk_bf16_f32 v116, v136, v137
v_cvt_pk_bf16_f32 v117, v138, v139
v_cvt_pk_bf16_f32 v118, v140, v141
v_cvt_pk_bf16_f32 v119, v142, v143
buffer_store_dwordx2 v[112:113], v53, s[16:19], s98 offen offset:0 sc1
buffer_store_dwordx2 v[114:115], v53, s[16:19], s98 offen offset:1024 sc1
buffer_store_dwordx2 v[116:117], v53, s[16:19], s98 offen offset:2048 sc1
buffer_store_dwordx2 v[118:119], v53, s[16:19], s98 offen offset:3072 sc1
s_waitcnt vmcnt(20)
ds_read_b128 v[160:163], v4 offset:0
ds_read_b128 v[164:167], v4 offset:1024
ds_read_b128 v[168:171], v4 offset:2048
ds_read_b128 v[172:175], v4 offset:3072
s_waitcnt lgkmcnt(2)
v_mfma_f32_32x32x16_bf16 v[192:207], a[0:3], v[160:163], 0
v_mfma_f32_32x32x16_bf16 v[208:223], a[0:3], v[164:167], 0
v_mfma_f32_32x32x16_bf16 v[224:239], a[4:7], v[160:163], 0
v_mfma_f32_32x32x16_bf16 v[240:255], a[4:7], v[164:167], 0
s_waitcnt vmcnt(18)
ds_read_b128 v[176:179], v4 offset:4096
ds_read_b128 v[180:183], v4 offset:5120
s_waitcnt lgkmcnt(2)
v_mfma_f32_32x32x16_bf16 v[192:207], a[8:11], v[168:171], v[192:207]
s_add_u32 m0, s43, 0
s_mov_b32 s48, s30
s_add_u32 s30, s30, 1024
s_cmp_eq_u32 s30, s31
s_cselect_b32 s30, s41, s30
buffer_load_dwordx4 v2, s[16:19], s48 offen sc1 lds
v_mfma_f32_32x32x16_bf16 v[208:223], a[8:11], v[172:175], v[208:223]
v_mfma_f32_32x32x16_bf16 v[224:239], a[12:15], v[168:171], v[224:239]
s_add_u32 m0, s43, 0
s_nop 0
buffer_load_dwordx4 v3, s[16:19], s48 offen offset:1024 sc1 lds
v_mfma_f32_32x32x16_bf16 v[240:255], a[12:15], v[172:175], v[240:255]
s_waitcnt vmcnt(18)
ds_read_b128 v[184:187], v4 offset:6144
ds_read_b128 v[188:191], v4 offset:7168
s_waitcnt lgkmcnt(2)
v_mfma_f32_32x32x16_bf16 v[192:207], a[16:19], v[176:179], v[192:207]
s_add_u32 m0, s43, 2048
s_mov_b32 s48, s30
s_add_u32 s30, s30, 1024
s_cmp_eq_u32 s30, s31
s_cselect_b32 s30, s41, s30
buffer_load_dwordx4 v2, s[16:19], s48 offen sc1 lds
v_mfma_f32_32x32x16_bf16 v[208:223], a[16:19], v[180:183], v[208:223]
v_mfma_f32_32x32x16_bf16 v[224:239], a[20:23], v[176:179], v[224:239]
s_add_u32 m0, s43, 2048
s_nop 0
buffer_load_dwordx4 v3, s[16:19], s48 offen offset:1024 sc1 lds
v_mfma_f32_32x32x16_bf16 v[240:255], a[20:23], v[180:183], v[240:255]
s_waitcnt vmcnt(18)
ds_read_b128 v[160:163], v4 offset:8192
ds_read_b128 v[164:167], v4 offset:9216
s_waitcnt lgkmcnt(2)
v_mfma_f32_32x32x16_bf16 v[192:207], a[24:27], v[184:187], v[192:207]
s_add_u32 m0, s43, 4096
s_mov_b32 s48, s30
s_add_u32 s30, s30, 1024
s_cmp_eq_u32 s30, s31
s_cselect_b32 s30, s41, s30
buffer_load_dwordx4 v2, s[16:19], s48 offen sc1 lds
v_mfma_f32_32x32x16_bf16 v[208:223], a[24:27], v[188:191], v[208:223]
v_mfma_f32_32x32x16_bf16 v[224:239], a[28:31], v[184:187], v[224:239]
s_add_u32 m0, s43, 4096
s_nop 0
buffer_load_dwordx4 v3, s[16:19], s48 offen offset:1024 sc1 lds
v_mfma_f32_32x32x16_bf16 v[240:255], a[28:31], v[188:191], v[240:255]
s_waitcnt vmcnt(18)
ds_read_b128 v[168:171], v4 offset:10240
ds_read_b128 v[172:175], v4 offset:11264
s_waitcnt lgkmcnt(2)
v_mfma_f32_32x32x16_bf16 v[192:207], a[32:35], v[160:163], v[192:207]
s_add_u32 m0, s43, 6144
s_mov_b32 s48, s30
s_add_u32 s30, s30, 1024
s_cmp_eq_u32 s30, s31
s_cselect_b32 s30, s41, s30
buffer_load_dwordx4 v2, s[16:19], s48 offen sc1 lds
v_mfma_f32_32x32x16_bf16 v[208:223], a[32:35], v[164:167], v[208:223]
v_mfma_f32_32x32x16_bf16 v[224:239], a[36:39], v[160:163], v[224:239]
s_add_u32 m0, s43, 6144
s_nop 0
buffer_load_dwordx4 v3, s[16:19], s48 offen offset:1024 sc1 lds
v_mfma_f32_32x32x16_bf16 v[240:255], a[36:39], v[164:167], v[240:255]
s_waitcnt vmcnt(18)
ds_read_b128 v[176:179], v4 offset:12288
ds_read_b128 v[180:183], v4 offset:13312
s_waitcnt lgkmcnt(2)
v_mfma_f32_32x32x16_bf16 v[192:207], a[40:43], v[168:171], v[192:207]
s_add_u32 m0, s43, 8192
s_mov_b32 s48, s30
s_add_u32 s30, s30, 1024
s_cmp_eq_u32 s30, s31
s_cselect_b32 s30, s41, s30
buffer_load_dwordx4 v2, s[16:19], s48 offen sc1 lds
v_mfma_f32_32x32x16_bf16 v[208:223], a[40:43], v[172:175], v[208:223]
v_mfma_f32_32x32x16_bf16 v[224:239], a[44:47], v[168:171], v[224:239]
s_add_u32 m0, s43, 8192
s_nop 0
buffer_load_dwordx4 v3, s[16:19], s48 offen offset:1024 sc1 lds
v_mfma_f32_32x32x16_bf16 v[240:255], a[44:47], v[172:175], v[240:255]
s_waitcnt vmcnt(18)
ds_read_b128 v[184:187], v4 offset:14336
ds_read_b128 v[188:191], v4 offset:15360
s_waitcnt lgkmcnt(2)
v_mfma_f32_32x32x16_bf16 v[192:207], a[48:51], v[176:179], v[192:207]
s_add_u32 m0, s43, 10240
s_mov_b32 s48, s30
s_add_u32 s30, s30, 1024
s_cmp_eq_u32 s30, s31
s_cselect_b32 s30, s41, s30
buffer_load_dwordx4 v2, s[16:19], s48 offen sc1 lds
v_mfma_f32_32x32x16_bf16 v[208:223], a[48:51], v[180:183], v[208:223]
v_mfma_f32_32x32x16_bf16 v[224:239], a[52:55], v[176:179], v[224:239]
s_add_u32 m0, s43, 10240
s_nop 0
buffer_load_dwordx4 v3, s[16:19], s48 offen offset:1024 sc1 lds
v_mfma_f32_32x32x16_bf16 v[240:255], a[52:55], v[180:183], v[240:255]
s_waitcnt vmcnt(18)
ds_read_b128 v[160:163], v4 offset:16384
ds_read_b128 v[164:167], v4 offset:17408
s_waitcnt lgkmcnt(2)
v_mfma_f32_32x32x16_bf16 v[192:207], a[56:59], v[184:187], v[192:207]
s_add_u32 m0, s43, 12288
s_mov_b32 s48, s30
s_add_u32 s30, s30, 1024
s_cmp_eq_u32 s30, s31
s_cselect_b32 s30, s41, s30
buffer_load_dwordx4 v2, s[16:19], s48 offen sc1 lds
v_mfma_f32_32x32x16_bf16 v[208:223], a[56:59], v[188:191], v[208:223]
v_mfma_f32_32x32x16_bf16 v[224:239], a[60:63], v[184:187], v[224:239]
s_add_u32 m0, s43, 12288
s_nop 0
buffer_load_dwordx4 v3, s[16:19], s48 offen offset:1024 sc1 lds
v_mfma_f32_32x32x16_bf16 v[240:255], a[60:63], v[188:191], v[240:255]
s_waitcnt vmcnt(18)
ds_read_b128 v[168:171], v4 offset:18432
ds_read_b128 v[172:175], v4 offset:19456
s_waitcnt lgkmcnt(2)
v_mfma_f32_32x32x16_bf16 v[192:207], a[64:67], v[160:163], v[192:207]
s_add_u32 m0, s43, 14336
s_mov_b32 s48, s30
s_add_u32 s30, s30, 1024
s_cmp_eq_u32 s30, s31
s_cselect_b32 s30, s41, s30
buffer_load_dwordx4 v2, s[16:19], s48 offen sc1 lds
s_waitcnt vmcnt(15)
s_lshl_b32 s32, s2, 2
s_add_u32 s32, s32, s36
s_lshl_b32 s32, s32, 6
s_add_u32 s32, s32, 196608
v_mov_b32 v52, 0
v_mov_b32 v53, s50
s_mov_b64 exec, 1
buffer_store_dword v53, v52, s[16:19], s32 offen sc1
s_mov_b64 exec, -1
v_mfma_f32_32x32x16_bf16 v[208:223], a[64:67], v[164:167], v[208:223]
v_mfma_f32_32x32x16_bf16 v[224:239], a[68:71], v[160:163], v[224:239]
s_add_u32 m0, s43, 14336
s_nop 0
buffer_load_dwordx4 v3, s[16:19], s48 offen offset:1024 sc1 lds
v_mfma_f32_32x32x16_bf16 v[240:255], a[68:71], v[164:167], v[240:255]
s_waitcnt vmcnt(15)
ds_read_b128 v[176:179], v4 offset:0
ds_read_b128 v[180:183], v4 offset:1024
s_waitcnt lgkmcnt(2)
v_mfma_f32_32x32x16_bf16 v[192:207], a[72:75], v[168:171], v[192:207]
s_add_u32 m0, s43, 16384
s_mov_b32 s48, s30
s_add_u32 s30, s30, 1024
s_cmp_eq_u32 s30, s31
s_cselect_b32 s30, s41, s30
buffer_load_dwordx4 v2, s[16:19], s48 offen sc1 lds
v_mfma_f32_32x32x16_bf16 v[208:223], a[72:75], v[172:175], v[208:223]
v_mfma_f32_32x32x16_bf16 v[224:239], a[76:79], v[168:171], v[224:239]
s_add_u32 m0, s43, 16384
s_nop 0
buffer_load_dwordx4 v3, s[16:19], s48 offen offset:1024 sc1 lds
v_mfma_f32_32x32x16_bf16 v[240:255], a[76:79], v[172:175], v[240:255]
s_waitcnt vmcnt(15)
ds_read_b128 v[184:187], v4 offset:2048
ds_read_b128 v[188:191], v4 offset:3072
s_waitcnt lgkmcnt(2)
v_mfma_f32_32x32x16_bf16 v[192:207], a[80:83], v[176:179], v[192:207]
s_add_u32 m0, s43, 18432
s_mov_b32 s48, s30
s_add_u32 s30, s30, 1024
s_cmp_eq_u32 s30, s31
s_cselect_b32 s30, s41, s30
buffer_load_dwordx4 v2, s[16:19], s48 offen sc1 lds
v_mfma_f32_32x32x16_bf16 v[208:223], a[80:83], v[180:183], v[208:223]
v_mfma_f32_32x32x16_bf16 v[224:239], a[84:87], v[176:179], v[224:239]
s_add_u32 m0, s43, 18432
s_nop 0
buffer_load_dwordx4 v3, s[16:19], s48 offen offset:1024 sc1 lds
v_mfma_f32_32x32x16_bf16 v[240:255], a[84:87], v[180:183], v[240:255]
s_waitcnt vmcnt(15)
ds_read_b128 v[160:163], v4 offset:4096
ds_read_b128 v[164:167], v4 offset:5120
s_waitcnt lgkmcnt(2)
v_mfma_f32_32x32x16_bf16 v[192:207], a[88:91], v[184:187], v[192:207]
s_add_u32 m0, s43, 0
s_mov_b32 s48, s30
s_add_u32 s30, s30, 1024
s_cmp_eq_u32 s30, s31
s_cselect_b32 s30, s41, s30
buffer_load_dwordx4 v2, s[16:19], s48 offen sc1 lds
v_mfma_f32_32x32x16_bf16 v[208:223], a[88:91], v[188:191], v[208:223]
v_mfma_f32_32x32x16_bf16 v[224:239], a[92:95], v[184:187], v[224:239]
s_add_u32 m0, s43, 0
s_nop 0
buffer_load_dwordx4 v3, s[16:19], s48 offen offset:1024 sc1 lds
v_mfma_f32_32x32x16_bf16 v[240:255], a[92:95], v[188:191], v[240:255]
s_waitcnt vmcnt(15)
ds_read_b128 v[168:171], v4 offset:6144
ds_read_b128 v[172:175], v4 offset:7168
s_waitcnt lgkmcnt(2)
v_mfma_f32_32x32x16_bf16 v[192:207], a[96:99], v[160:163], v[192:207]
s_add_u32 m0, s43, 2048
s_mov_b32 s48, s30
s_add_u32 s30, s30, 1024
s_cmp_eq_u32 s30, s31
s_cselect_b32 s30, s41, s30
buffer_load_dwordx4 v2, s[16:19], s48 offen sc1 lds
v_mfma_f32_32x32x16_bf16 v[208:223], a[96:99], v[164:167], v[208:223]
v_mfma_f32_32x32x16_bf16 v[224:239], a[100:103], v[160:163], v[224:239]
s_add_u32 m0, s43, 2048
s_nop 0
buffer_load_dwordx4 v3, s[16:19], s48 offen offset:1024 sc1 lds
v_mfma_f32_32x32x16_bf16 v[240:255], a[100:103], v[164:167], v[240:255]
s_waitcnt vmcnt(15)
ds_read_b128 v[176:179], v4 offset:8192
ds_read_b128 v[180:183], v4 offset:9216
s_waitcnt lgkmcnt(2)
v_mfma_f32_32x32x16_bf16 v[192:207], a[104:107], v[168:171], v[192:207]
s_add_u32 m0, s43, 4096
s_mov_b32 s48, s30
s_add_u32 s30, s30, 1024
s_cmp_eq_u32 s30, s31
s_cselect_b32 s30, s41, s30
buffer_load_dwordx4 v2, s[16:19], s48 offen sc1 lds
v_mfma_f32_32x32x16_bf16 v[208:223], a[104:107], v[172:175], v[208:223]
v_mfma_f32_32x32x16_bf16 v[224:239], a[108:111], v[168:171], v[224:239]
s_add_u32 m0, s43, 4096
s_nop 0
buffer_load_dwordx4 v3, s[16:19], s48 offen offset:1024 sc1 lds
v_mfma_f32_32x32x16_bf16 v[240:255], a[108:111], v[172:175], v[240:255]
s_waitcnt vmcnt(15)
ds_read_b128 v[184:187], v4 offset:10240
ds_read_b128 v[188:191], v4 offset:11264
s_waitcnt lgkmcnt(2)
v_mfma_f32_32x32x16_bf16 v[192:207], a[112:115], v[176:179], v[192:207]
s_add_u32 m0, s43, 6144
s_mov_b32 s48, s30
s_add_u32 s30, s30, 1024
s_cmp_eq_u32 s30, s31
s_cselect_b32 s30, s41, s30
buffer_load_dwordx4 v2, s[16:19], s48 offen sc1 lds
v_lshrrev_b32 v26, 3, v1
v_and_b32 v27, 7, v1
v_lshrrev_b32 v24, 4, v1
v_xor_b32 v25, v27, v24
v_mul_u32_u24 v26, 896, v26
v_lshl_add_u32 v25, v25, 4, v26
v_xor_b32 v27, 4, v27
v_mfma_f32_32x32x16_bf16 v[208:223], a[112:115], v[180:183], v[208:223]
v_xor_b32 v27, v27, v24
v_lshl_add_u32 v26, v27, 4, v26
v_add_u32 v26, 6144, v26
s_lshl_b32 s45, s37, 7
s_lshl_b32 s46, s52, 6
s_add_u32 s45, s45, s46
v_mfma_f32_32x32x16_bf16 v[224:239], a[116:119], v[176:179], v[224:239]
s_add_u32 m0, s43, 6144
s_nop 0
buffer_load_dwordx4 v3, s[16:19], s48 offen offset:1024 sc1 lds
s_lshl_b32 s46, s36, 4
s_add_u32 s46, s46, s45
s_mul_i32 s46, s46, 896
s_lshl_b32 s47, s53, 7
s_add_u32 s46, s46, s47
s_add_u32 m0, s3, 114688
s_nop 0
buffer_load_dwordx4 v25, s[4:7], s46 offen lds
buffer_load_dwordx4 v26, s[4:7], s46 offen offset:1024 lds
v_mfma_f32_32x32x16_bf16 v[240:255], a[116:119], v[180:183], v[240:255]
s_lshl_b32 s46, s39, 5
s_add_u32 s45, s45, s46
s_mul_i32 s54, s45, 896
s_add_u32 s54, s54, s47
s_lshl_b32 s46, s40, 6
s_add_u32 s54, s54, s46
s_waitcnt vmcnt(17)
ds_read_b128 v[160:163], v4 offset:12288
ds_read_b128 v[164:167], v4 offset:13312
s_waitcnt lgkmcnt(2)
v_mfma_f32_32x32x16_bf16 v[192:207], a[120:123], v[184:187], v[192:207]
s_add_u32 m0, s43, 8192
s_mov_b32 s48, s30
s_add_u32 s30, s30, 1024
s_cmp_eq_u32 s30, s31
s_cselect_b32 s30, s41, s30
buffer_load_dwordx4 v2, s[16:19], s48 offen sc1 lds
v_mfma_f32_32x32x16_bf16 v[208:223], a[120:123], v[188:191], v[208:223]
v_mfma_f32_32x32x16_bf16 v[224:239], a[124:127], v[184:187], v[224:239]
s_add_u32 m0, s43, 8192
s_nop 0
buffer_load_dwordx4 v3, s[16:19], s48 offen offset:1024 sc1 lds
v_mfma_f32_32x32x16_bf16 v[240:255], a[124:127], v[188:191], v[240:255]
s_waitcnt vmcnt(16)
ds_read_b128 v[168:171], v4 offset:14336
ds_read_b128 v[172:175], v4 offset:15360
s_waitcnt lgkmcnt(2)
v_mfma_f32_32x32x16_bf16 v[192:207], a[128:131], v[160:163], v[192:207]
s_add_u32 m0, s43, 10240
s_mov_b32 s48, s30
s_add_u32 s30, s30, 1024
s_cmp_eq_u32 s30, s31
s_cselect_b32 s30, s41, s30
buffer_load_dwordx4 v2, s[16:19], s48 offen sc1 lds
v_mfma_f32_32x32x16_bf16 v[208:223], a[128:131], v[164:167], v[208:223]
v_mfma_f32_32x32x16_bf16 v[224:239], a[132:135], v[160:163], v[224:239]
s_add_u32 m0, s43, 10240
s_nop 0
buffer_load_dwordx4 v3, s[16:19], s48 offen offset:1024 sc1 lds
v_mfma_f32_32x32x16_bf16 v[240:255], a[132:135], v[164:167], v[240:255]
s_waitcnt vmcnt(16)
ds_read_b128 v[176:179], v4 offset:16384
ds_read_b128 v[180:183], v4 offset:17408
s_waitcnt lgkmcnt(2)
v_mfma_f32_32x32x16_bf16 v[192:207], a[136:139], v[168:171], v[192:207]
s_add_u32 m0, s43, 12288
s_mov_b32 s48, s30
s_add_u32 s30, s30, 1024
s_cmp_eq_u32 s30, s31
s_cselect_b32 s30, s41, s30
buffer_load_dwordx4 v2, s[16:19], s48 offen sc1 lds
v_and_b32 v28, 31, v1
v_lshlrev_b32 v28, 1, v28
v_lshrrev_b32 v27, 5, v1
v_lshl_add_u32 v28, v27, 14, v28
s_lshl_b32 s45, s53, 5
s_lshl_b32 s46, s40, 4
s_add_u32 s45, s45, s46
v_mfma_f32_32x32x16_bf16 v[208:223], a[136:139], v[172:175], v[208:223]
s_lshl_b32 s55, s45, 8
s_lshl_b32 s45, s45, 13
s_lshl_b32 s46, s37, 7
s_lshl_b32 s47, s52, 6
s_add_u32 s46, s46, s47
s_lshl_b32 s47, s39, 5
v_mfma_f32_32x32x16_bf16 v[224:239], a[140:143], v[168:171], v[224:239]
s_add_u32 m0, s43, 12288
s_nop 0
buffer_load_dwordx4 v3, s[16:19], s48 offen offset:1024 sc1 lds
s_add_u32 s46, s46, s47
s_lshl_b32 s46, s46, 1
s_add_u32 s45, s45, s46
s_add_u32 s49, s45, 2162688
s_bfe_u32 s46, s37, 0x10001
s_lshl_b32 s46, s46, 6
s_add_u32 s55, s55, s46
v_mfma_f32_32x32x16_bf16 v[240:255], a[140:143], v[172:175], v[240:255]
s_add_u32 s55, s55, 196608
v_min_u32 v126, 31, v1
v_lshrrev_b32 v127, 1, v126
v_and_b32 v126, 1, v126
v_lshlrev_b32 v126, 7, v126
v_lshl_add_u32 v126, v127, 8, v126
s_waitcnt vmcnt(16)
ds_read_b128 v[184:187], v4 offset:18432
ds_read_b128 v[188:191], v4 offset:19456
s_waitcnt lgkmcnt(2)
v_mfma_f32_32x32x16_bf16 v[192:207], a[144:147], v[176:179], v[192:207]
s_add_u32 m0, s43, 14336
s_mov_b32 s48, s30
s_add_u32 s30, s30, 1024
s_cmp_eq_u32 s30, s31
s_cselect_b32 s30, s41, s30
buffer_load_dwordx4 v2, s[16:19], s48 offen sc1 lds
v_mfma_f32_32x32x16_bf16 v[208:223], a[144:147], v[180:183], v[208:223]
v_mfma_f32_32x32x16_bf16 v[224:239], a[148:151], v[176:179], v[224:239]
s_add_u32 m0, s43, 14336
s_nop 0
buffer_load_dwordx4 v3, s[16:19], s48 offen offset:1024 sc1 lds
v_mfma_f32_32x32x16_bf16 v[240:255], a[148:151], v[180:183], v[240:255]
s_waitcnt vmcnt(16)
ds_read_b128 v[160:163], v4 offset:0
ds_read_b128 v[164:167], v4 offset:1024
s_waitcnt lgkmcnt(2)
v_mfma_f32_32x32x16_bf16 v[192:207], a[152:155], v[184:187], v[192:207]
v_mfma_f32_32x32x16_bf16 v[208:223], a[152:155], v[188:191], v[208:223]
v_mfma_f32_32x32x16_bf16 v[224:239], a[156:159], v[184:187], v[224:239]
v_mfma_f32_32x32x16_bf16 v[240:255], a[156:159], v[188:191], v[240:255]
s_waitcnt vmcnt(14)
ds_read_b128 v[168:171], v4 offset:2048
ds_read_b128 v[172:175], v4 offset:3072
s_waitcnt lgkmcnt(2)
v_mfma_f32_32x32x16_bf16 v[192:207], a[160:163], v[160:163], v[192:207]
v_and_b32 v22, 31, v1
v_lshlrev_b32 v22, 3, v22
s_lshl_b32 s45, s37, 10
s_lshl_b32 s46, s52, 9
v_mfma_f32_32x32x16_bf16 v[208:223], a[160:163], v[164:167], v[208:223]
s_add_u32 s45, s45, s46
s_lshl_b32 s46, s39, 8
s_add_u32 s45, s45, s46
v_mfma_f32_32x32x16_bf16 v[224:239], a[164:167], v[160:163], v[224:239]
s_add_u32 s45, s45, 262144
buffer_load_dwordx2 v[30:31], v22, s[16:19], s45 offen sc1
v_and_b32 v29, 31, v1
v_mfma_f32_32x32x16_bf16 v[240:255], a[164:167], v[164:167], v[240:255]
v_mul_u32_u24 v29, 896, v29
v_lshrrev_b32 v27, 5, v1
v_lshl_add_u32 v29, v27, 4, v29
s_waitcnt vmcnt(13)
ds_read_b128 v[176:179], v4 offset:4096
ds_read_b128 v[180:183], v4 offset:5120
s_waitcnt lgkmcnt(2)
v_mfma_f32_32x32x16_bf16 v[192:207], a[168:171], v[168:171], v[192:207]
v_mfma_f32_32x32x16_bf16 v[208:223], a[168:171], v[172:175], v[208:223]
v_mfma_f32_32x32x16_bf16 v[224:239], a[172:175], v[168:171], v[224:239]
v_mfma_f32_32x32x16_bf16 v[240:255], a[172:175], v[172:175], v[240:255]
s_waitcnt vmcnt(11)
ds_read_b128 v[184:187], v4 offset:6144
ds_read_b128 v[188:191], v4 offset:7168
s_waitcnt lgkmcnt(2)
v_mfma_f32_32x32x16_bf16 v[192:207], a[176:179], v[176:179], v[192:207]
v_mfma_f32_32x32x16_bf16 v[208:223], a[176:179], v[180:183], v[208:223]
v_mfma_f32_32x32x16_bf16 v[224:239], a[180:183], v[176:179], v[224:239]
v_mfma_f32_32x32x16_bf16 v[240:255], a[180:183], v[180:183], v[240:255]
s_waitcnt vmcnt(7)
ds_read_b128 v[160:163], v4 offset:8192
ds_read_b128 v[164:167], v4 offset:9216
s_waitcnt lgkmcnt(2)
v_mfma_f32_32x32x16_bf16 v[192:207], a[184:187], v[184:187], v[192:207]
buffer_load_dword v127, v126, s[16:19], s55 offen sc1
v_mfma_f32_32x32x16_bf16 v[208:223], a[184:187], v[188:191], v[208:223]
v_mfma_f32_32x32x16_bf16 v[224:239], a[188:191], v[184:187], v[224:239]
v_mfma_f32_32x32x16_bf16 v[240:255], a[188:191], v[188:191], v[240:255]
s_waitcnt vmcnt(6)
ds_read_b128 v[168:171], v4 offset:10240
ds_read_b128 v[172:175], v4 offset:11264
s_waitcnt vmcnt(2)
ds_read_b128 v[176:179], v4 offset:12288
ds_read_b128 v[180:183], v4 offset:13312
ds_read_b128 v[184:187], v4 offset:14336
ds_read_b128 v[188:191], v4 offset:15360
v_add_u32 v22, s43, v18
s_xor_b32 s45, s36, 1
s_mul_i32 s45, s45, 20480
v_add_u32 v23, s45, v18
s_xor_b32 s45, s36, 2
s_mul_i32 s45, s45, 20480
v_add_u32 v24, s45, v18
s_xor_b32 s45, s36, 3
s_mul_i32 s45, s45, 20480
v_add_u32 v25, s45, v18
s_waitcnt lgkmcnt(0)
v_mfma_f32_32x32x16_bf16 v[208:223], a[192:195], v[164:167], v[208:223]
v_mfma_f32_32x32x16_bf16 v[208:223], a[200:203], v[172:175], v[208:223]
v_mfma_f32_32x32x16_bf16 v[208:223], a[208:211], v[180:183], v[208:223]
v_mfma_f32_32x32x16_bf16 v[208:223], a[216:219], v[188:191], v[208:223]
v_mfma_f32_32x32x16_bf16 v[224:239], a[196:199], v[160:163], v[224:239]
s_nop 4
v_mfma_f32_32x32x16_bf16 v[224:239], a[204:207], v[168:171], v[224:239]
s_nop 4
v_mfma_f32_32x32x16_bf16 v[224:239], a[212:215], v[176:179], v[224:239]
ds_write_b128 v22, v[208:211] offset:4096
v_mfma_f32_32x32x16_bf16 v[224:239], a[220:223], v[184:187], v[224:239]
ds_write_b128 v22, v[212:215] offset:5120
v_mfma_f32_32x32x16_bf16 v[240:255], a[196:199], v[164:167], v[240:255]
ds_write_b128 v22, v[216:219] offset:6144
v_mfma_f32_32x32x16_bf16 v[240:255], a[204:207], v[172:175], v[240:255]
ds_write_b128 v22, v[220:223] offset:7168
v_mfma_f32_32x32x16_bf16 v[240:255], a[212:215], v[180:183], v[240:255]
s_nop 4
v_mfma_f32_32x32x16_bf16 v[240:255], a[220:223], v[188:191], v[240:255]
s_nop 4
v_mfma_f32_32x32x16_bf16 v[192:207], a[192:195], v[160:163], v[192:207]
ds_write_b128 v22, v[224:227] offset:8192
v_mfma_f32_32x32x16_bf16 v[192:207], a[200:203], v[168:171], v[192:207]
ds_write_b128 v22, v[228:231] offset:9216
v_mfma_f32_32x32x16_bf16 v[192:207], a[208:211], v[176:179], v[192:207]
ds_write_b128 v22, v[232:235] offset:10240
v_mfma_f32_32x32x16_bf16 v[192:207], a[216:219], v[184:187], v[192:207]
ds_write_b128 v22, v[236:239] offset:11264
s_nop 7
s_nop 4
s_nop 4
ds_write_b128 v22, v[240:243] offset:12288
ds_write_b128 v22, v[244:247] offset:13312
ds_write_b128 v22, v[248:251] offset:14336
ds_write_b128 v22, v[252:255] offset:15360
s_waitcnt vmcnt(0)
v_cmp_ne_u32 vcc, s50, v127
s_cbranch_vccz G_p3_done
    s_mov_b32 s51, 0x8000
    G_p3_loop:
    buffer_load_dword v127, v126, s[16:19], s55 offen sc1
    s_waitcnt vmcnt(0)
    v_cmp_ne_u32 vcc, s50, v127
    s_cbranch_vccz G_p3_done
    s_sleep 1
    s_sub_u32 s51, s51, 1
    s_cmp_lg_u32 s51, 0
    s_cbranch_scc1 G_p3_loop
    G_p3_done:

s_add_u32 s47, s49, 0
buffer_load_ushort v64, v28, s[16:19], s47 offen sc1
s_add_u32 s47, s49, 4096
buffer_load_ushort v65, v28, s[16:19], s47 offen sc1
s_add_u32 s47, s49, 8192
buffer_load_ushort v66, v28, s[16:19], s47 offen sc1
s_add_u32 s47, s49, 12288
buffer_load_ushort v67, v28, s[16:19], s47 offen sc1
s_add_u32 s47, s49, 32768
buffer_load_ushort v68, v28, s[16:19], s47 offen sc1
s_add_u32 s47, s49, 36864
buffer_load_ushort v69, v28, s[16:19], s47 offen sc1
s_add_u32 s47, s49, 40960
buffer_load_ushort v70, v28, s[16:19], s47 offen sc1
s_add_u32 s47, s49, 45056
buffer_load_ushort v71, v28, s[16:19], s47 offen sc1
s_add_u32 s47, s49, 65536
buffer_load_ushort v72, v28, s[16:19], s47 offen sc1
s_add_u32 s47, s49, 69632
buffer_load_ushort v73, v28, s[16:19], s47 offen sc1
s_add_u32 s47, s49, 73728
buffer_load_ushort v74, v28, s[16:19], s47 offen sc1
s_add_u32 s47, s49, 77824
buffer_load_ushort v75, v28, s[16:19], s47 offen sc1
s_add_u32 s47, s49, 98304
buffer_load_ushort v76, v28, s[16:19], s47 offen sc1
s_add_u32 s47, s49, 102400
buffer_load_ushort v77, v28, s[16:19], s47 offen sc1
s_add_u32 s47, s49, 106496
buffer_load_ushort v78, v28, s[16:19], s47 offen sc1
s_add_u32 s47, s49, 110592
buffer_load_ushort v79, v28, s[16:19], s47 offen sc1
s_waitcnt vmcnt(26)
s_waitcnt lgkmcnt(0)
s_barrier
v_and_b32 v56, 31, v1
v_bfe_u32 v57, v1, 1, 3
s_lshl_b32 s45, s40, 2
v_xor_b32 v57, s45, v57
s_lshl_b32 s46, s39, 12
s_add_u32 s46, s46, 114688
v_lshl_add_u32 v56, v56, 7, s46
v_lshrrev_b32 v58, 5, v1
v_lshl_add_u32 v56, v58, 3, v56
v_xor_b32 v58, 0, v57
v_lshl_add_u32 v58, v58, 4, v56
ds_read_b64 v[32:33], v58
v_xor_b32 v58, 1, v57
v_lshl_add_u32 v58, v58, 4, v56
ds_read_b64 v[34:35], v58
v_xor_b32 v58, 2, v57
v_lshl_add_u32 v58, v58, 4, v56
ds_read_b64 v[36:37], v58
v_xor_b32 v58, 3, v57
v_lshl_add_u32 v58, v58, 4, v56
ds_read_b64 v[38:39], v58
ds_read_b128 v[208:211], v23 offset:4096
ds_read_b128 v[212:215], v23 offset:5120
ds_read_b128 v[216:219], v23 offset:6144
ds_read_b128 v[220:223], v23 offset:7168
ds_read_b128 v[224:227], v24 offset:8192
ds_read_b128 v[228:231], v24 offset:9216
ds_read_b128 v[232:235], v24 offset:10240
ds_read_b128 v[236:239], v24 offset:11264
ds_read_b128 v[240:243], v25 offset:12288
ds_read_b128 v[244:247], v25 offset:13312
ds_read_b128 v[248:251], v25 offset:14336
ds_read_b128 v[252:255], v25 offset:15360
s_waitcnt lgkmcnt(8)
v_pk_add_f32 v[192:193], v[192:193], v[208:209]
v_pk_add_f32 v[194:195], v[194:195], v[210:211]
v_pk_add_f32 v[196:197], v[196:197], v[212:213]
v_pk_add_f32 v[198:199], v[198:199], v[214:215]
v_pk_add_f32 v[200:201], v[200:201], v[216:217]
v_pk_add_f32 v[202:203], v[202:203], v[218:219]
v_pk_add_f32 v[204:205], v[204:205], v[220:221]
v_pk_add_f32 v[206:207], v[206:207], v[222:223]
s_waitcnt lgkmcnt(4)
v_pk_add_f32 v[192:193], v[192:193], v[224:225]
v_pk_add_f32 v[194:195], v[194:195], v[226:227]
v_pk_add_f32 v[196:197], v[196:197], v[228:229]
v_pk_add_f32 v[198:199], v[198:199], v[230:231]
v_pk_add_f32 v[200:201], v[200:201], v[232:233]
v_pk_add_f32 v[202:203], v[202:203], v[234:235]
v_pk_add_f32 v[204:205], v[204:205], v[236:237]
v_pk_add_f32 v[206:207], v[206:207], v[238:239]
s_waitcnt lgkmcnt(0)
v_pk_add_f32 v[192:193], v[192:193], v[240:241]
v_pk_add_f32 v[194:195], v[194:195], v[242:243]
v_pk_add_f32 v[196:197], v[196:197], v[244:245]
v_pk_add_f32 v[198:199], v[198:199], v[246:247]
v_pk_add_f32 v[200:201], v[200:201], v[248:249]
v_pk_add_f32 v[202:203], v[202:203], v[250:251]
v_pk_add_f32 v[204:205], v[204:205], v[252:253]
v_pk_add_f32 v[206:207], v[206:207], v[254:255]
    s_waitcnt vmcnt(0)
    v_rcp_f32 v31, v31
    v_mov_b32 v20, 0xbfb8aa3b
    v_mov_b32 v21, 1.0
    v_mul_f32 v30, v30, v31
    v_sub_f32 v30, 0, v30

v_pk_mul_f32 v[80:81], v[192:193], v[20:21] op_sel_hi:[1,0]
v_pk_mul_f32 v[82:83], v[194:195], v[20:21] op_sel_hi:[1,0]
v_pk_mul_f32 v[84:85], v[196:197], v[20:21] op_sel_hi:[1,0]
v_pk_mul_f32 v[86:87], v[198:199], v[20:21] op_sel_hi:[1,0]
v_pk_mul_f32 v[88:89], v[200:201], v[20:21] op_sel_hi:[1,0]
v_pk_mul_f32 v[90:91], v[202:203], v[20:21] op_sel_hi:[1,0]
v_pk_mul_f32 v[92:93], v[204:205], v[20:21] op_sel_hi:[1,0]
v_pk_mul_f32 v[94:95], v[206:207], v[20:21] op_sel_hi:[1,0]
v_exp_f32 v80, v80
v_exp_f32 v81, v81
v_exp_f32 v82, v82
v_exp_f32 v83, v83
v_exp_f32 v84, v84
v_exp_f32 v85, v85
v_exp_f32 v86, v86
v_exp_f32 v87, v87
v_exp_f32 v88, v88
v_exp_f32 v89, v89
v_exp_f32 v90, v90
v_exp_f32 v91, v91
v_exp_f32 v92, v92
v_exp_f32 v93, v93
v_exp_f32 v94, v94
v_exp_f32 v95, v95
v_lshlrev_b32 v48, 16, v32
v_and_b32 v49, 0xffff0000, v32
v_lshlrev_b32 v50, 16, v33
v_and_b32 v51, 0xffff0000, v33
v_lshlrev_b32 v52, 16, v34
v_and_b32 v53, 0xffff0000, v34
v_lshlrev_b32 v54, 16, v35
v_and_b32 v55, 0xffff0000, v35
v_lshlrev_b32 v56, 16, v36
v_and_b32 v57, 0xffff0000, v36
v_lshlrev_b32 v58, 16, v37
v_and_b32 v59, 0xffff0000, v37
v_lshlrev_b32 v60, 16, v38
v_and_b32 v61, 0xffff0000, v38
v_lshlrev_b32 v62, 16, v39
v_and_b32 v63, 0xffff0000, v39
v_pk_add_f32 v[80:81], v[80:81], v[20:21] op_sel:[0,1] op_sel_hi:[1,1]
v_pk_add_f32 v[82:83], v[82:83], v[20:21] op_sel:[0,1] op_sel_hi:[1,1]
v_pk_add_f32 v[84:85], v[84:85], v[20:21] op_sel:[0,1] op_sel_hi:[1,1]
v_pk_add_f32 v[86:87], v[86:87], v[20:21] op_sel:[0,1] op_sel_hi:[1,1]
v_pk_add_f32 v[88:89], v[88:89], v[20:21] op_sel:[0,1] op_sel_hi:[1,1]
v_pk_add_f32 v[90:91], v[90:91], v[20:21] op_sel:[0,1] op_sel_hi:[1,1]
v_pk_add_f32 v[92:93], v[92:93], v[20:21] op_sel:[0,1] op_sel_hi:[1,1]
v_pk_add_f32 v[94:95], v[94:95], v[20:21] op_sel:[0,1] op_sel_hi:[1,1]
v_lshlrev_b32 v64, 16, v64
v_lshlrev_b32 v65, 16, v65
v_lshlrev_b32 v66, 16, v66
v_lshlrev_b32 v67, 16, v67
v_lshlrev_b32 v68, 16, v68
v_lshlrev_b32 v69, 16, v69
v_lshlrev_b32 v70, 16, v70
v_lshlrev_b32 v71, 16, v71
v_lshlrev_b32 v72, 16, v72
v_lshlrev_b32 v73, 16, v73
v_lshlrev_b32 v74, 16, v74
v_lshlrev_b32 v75, 16, v75
v_lshlrev_b32 v76, 16, v76
v_lshlrev_b32 v77, 16, v77
v_lshlrev_b32 v78, 16, v78
v_lshlrev_b32 v79, 16, v79
v_rcp_f32 v80, v80
v_rcp_f32 v81, v81
v_rcp_f32 v82, v82
v_rcp_f32 v83, v83
v_rcp_f32 v84, v84
v_rcp_f32 v85, v85
v_rcp_f32 v86, v86
v_rcp_f32 v87, v87
v_rcp_f32 v88, v88
v_rcp_f32 v89, v89
v_rcp_f32 v90, v90
v_rcp_f32 v91, v91
v_rcp_f32 v92, v92
v_rcp_f32 v93, v93
v_rcp_f32 v94, v94
v_rcp_f32 v95, v95
v_pk_fma_f32 v[96:97], v[48:49], v[30:31], v[30:31] op_sel:[0,1,0] op_sel_hi:[1,1,0]
v_pk_fma_f32 v[98:99], v[50:51], v[30:31], v[30:31] op_sel:[0,1,0] op_sel_hi:[1,1,0]
v_pk_fma_f32 v[100:101], v[52:53], v[30:31], v[30:31] op_sel:[0,1,0] op_sel_hi:[1,1,0]
v_pk_fma_f32 v[102:103], v[54:55], v[30:31], v[30:31] op_sel:[0,1,0] op_sel_hi:[1,1,0]
v_pk_fma_f32 v[104:105], v[56:57], v[30:31], v[30:31] op_sel:[0,1,0] op_sel_hi:[1,1,0]
v_pk_fma_f32 v[106:107], v[58:59], v[30:31], v[30:31] op_sel:[0,1,0] op_sel_hi:[1,1,0]
v_pk_fma_f32 v[108:109], v[60:61], v[30:31], v[30:31] op_sel:[0,1,0] op_sel_hi:[1,1,0]
v_pk_fma_f32 v[110:111], v[62:63], v[30:31], v[30:31] op_sel:[0,1,0] op_sel_hi:[1,1,0]
v_pk_mul_f32 v[80:81], v[80:81], v[192:193]
v_pk_mul_f32 v[82:83], v[82:83], v[194:195]
v_pk_mul_f32 v[84:85], v[84:85], v[196:197]
v_pk_mul_f32 v[86:87], v[86:87], v[198:199]
v_pk_mul_f32 v[88:89], v[88:89], v[200:201]
v_pk_mul_f32 v[90:91], v[90:91], v[202:203]
v_pk_mul_f32 v[92:93], v[92:93], v[204:205]
v_pk_mul_f32 v[94:95], v[94:95], v[206:207]
v_pk_mul_f32 v[64:65], v[64:65], v[96:97]
v_pk_mul_f32 v[66:67], v[66:67], v[98:99]
v_pk_mul_f32 v[68:69], v[68:69], v[100:101]
v_pk_mul_f32 v[70:71], v[70:71], v[102:103]
v_pk_mul_f32 v[72:73], v[72:73], v[104:105]
v_pk_mul_f32 v[74:75], v[74:75], v[106:107]
v_pk_mul_f32 v[76:77], v[76:77], v[108:109]
v_pk_mul_f32 v[78:79], v[78:79], v[110:111]
v_pk_fma_f32 v[80:81], v[80:81], v[64:65], v[48:49]
v_pk_fma_f32 v[82:83], v[82:83], v[66:67], v[50:51]
v_pk_fma_f32 v[84:85], v[84:85], v[68:69], v[52:53]
v_pk_fma_f32 v[86:87], v[86:87], v[70:71], v[54:55]
v_pk_fma_f32 v[88:89], v[88:89], v[72:73], v[56:57]
v_pk_fma_f32 v[90:91], v[90:91], v[74:75], v[58:59]
v_pk_fma_f32 v[92:93], v[92:93], v[76:77], v[60:61]
v_pk_fma_f32 v[94:95], v[94:95], v[78:79], v[62:63]
v_cvt_pk_bf16_f32 v112, v80, v81
v_cvt_pk_bf16_f32 v113, v82, v83
v_cvt_pk_bf16_f32 v114, v84, v85
v_cvt_pk_bf16_f32 v115, v86, v87
v_cvt_pk_bf16_f32 v116, v88, v89
v_cvt_pk_bf16_f32 v117, v90, v91
v_cvt_pk_bf16_f32 v118, v92, v93
v_cvt_pk_bf16_f32 v119, v94, v95
s_nop 1
v_permlane32_swap_b32 v112, v114
v_permlane32_swap_b32 v113, v115
v_permlane32_swap_b32 v116, v118
v_permlane32_swap_b32 v117, v119
buffer_store_dwordx4 v[112:115], v29, s[8:11], s54 offen offset:0
buffer_store_dwordx4 v[116:119], v29, s[8:11], s54 offen offset:32
s_waitcnt vmcnt(0)
s_endpgm
L_spare:
s_cmp_ge_u32 s2, 256
s_cbranch_scc1 L_end
s_load_dwordx2 s[4:5], s[0:1], 0
s_load_dwordx2 s[8:9], s[0:1], 56
s_load_dwordx2 s[12:13], s[0:1], 64
s_load_dwordx2 s[16:17], s[0:1], 96
s_load_dwordx2 s[20:21], s[0:1], 8
s_load_dwordx2 s[24:25], s[0:1], 16
s_load_dwordx2 s[28:29], s[0:1], 24
    v_and_b32 v1, 63, v0
    v_lshrrev_b32 v2, 6, v0
    s_sub_u32 s37, s2, 224
    v_readfirstlane_b32 s36, v2
    v_and_b32 v3, 15, v1
    v_lshrrev_b32 v4, 4, v1
    s_lshl_b32 s45, s36, 4
    v_add_u32 v5, s45, v3
    v_mul_u32_u24 v5, 896, v5
    v_lshl_add_u32 v5, v4, 4, v5
    s_and_b32 s45, s37, 7
    s_lshr_b32 s46, s37, 3
    s_lshr_b32 s47, s45, 1
    s_and_b32 s45, s45, 1
    s_lshl_b32 s52, s47, 3
    s_lshl_b32 s53, s45, 2
    s_add_u32 s52, s52, s53
    s_add_u32 s52, s52, s46
    s_lshl_b32 s53, s47, 2
    s_add_u32 s53, s53, s46
    s_mul_i32 s54, s45, 7
    s_mul_i32 s41, s52, 57344
    s_lshl_b32 s45, s36, 2
    v_add_u32 v6, s45, v4
    v_mul_u32_u24 v6, 3584, v6
    v_lshl_add_u32 v6, v3, 4, v6
    s_cmp_ge_u32 s53, 7
    s_cselect_b32 s46, 7, 0
    s_sub_u32 s38, s53, s46
    s_add_u32 s38, s38, s54
    s_lshl_b32 s42, s38, 8
    s_waitcnt lgkmcnt(0)

s_mov_b32 s51, 0
s_load_dword s50, s[16:17], s51
s_cmp_ge_u32 s53, 7
    s_cselect_b32 s32, s12, s8
    s_cselect_b32 s33, s13, s9
s_and_b32 s5, s5, 0xffff
s_mov_b32 s6, 1835008
s_mov_b32 s7, 0x20000
s_and_b32 s33, s33, 0xffff
s_mov_b32 s34, 1605632
s_mov_b32 s35, 0x20000
s_and_b32 s17, s17, 0xffff
s_mov_b32 s18, 11337728
s_mov_b32 s19, 0x20000
s_and_b32 s21, s21, 0xffff
s_mov_b32 s22, 1835008
s_mov_b32 s23, 0x20000
s_and_b32 s25, s25, 0xffff
s_mov_b32 s26, 1835008
s_mov_b32 s27, 0x20000
s_and_b32 s29, s29, 0xffff
s_mov_b32 s30, 3584
s_mov_b32 s31, 0x20000
v_lshlrev_b32 v7, 4, v1
s_cmp_ge_u32 s53, 14
s_cbranch_scc1 SP_noC1
s_mov_b32 s48, s42
buffer_load_dwordx4 v[72:75], v6, s[32:35], s48 offen
s_add_u32 s48, s48, 57344
buffer_load_dwordx4 v[76:79], v6, s[32:35], s48 offen
s_add_u32 s48, s48, 57344
buffer_load_dwordx4 v[80:83], v6, s[32:35], s48 offen
s_add_u32 s48, s48, 57344
buffer_load_dwordx4 v[84:87], v6, s[32:35], s48 offen
s_add_u32 s48, s48, 57344
buffer_load_dwordx4 v[88:91], v6, s[32:35], s48 offen
s_add_u32 s48, s48, 57344
buffer_load_dwordx4 v[92:95], v6, s[32:35], s48 offen
s_add_u32 s48, s48, 57344
buffer_load_dwordx4 v[96:99], v6, s[32:35], s48 offen
s_add_u32 s48, s48, 57344
buffer_load_dwordx4 v[100:103], v6, s[32:35], s48 offen
s_add_u32 s48, s48, 57344
buffer_load_dwordx4 v[104:107], v6, s[32:35], s48 offen
s_add_u32 s48, s48, 57344
buffer_load_dwordx4 v[108:111], v6, s[32:35], s48 offen
s_add_u32 s48, s48, 57344
buffer_load_dwordx4 v[112:115], v6, s[32:35], s48 offen
s_add_u32 s48, s48, 57344
buffer_load_dwordx4 v[116:119], v6, s[32:35], s48 offen
s_add_u32 s48, s48, 57344
buffer_load_dwordx4 v[120:123], v6, s[32:35], s48 offen
s_add_u32 s48, s48, 57344
buffer_load_dwordx4 v[124:127], v6, s[32:35], s48 offen
s_add_u32 s48, s48, 57344
buffer_load_dwordx4 v[128:131], v6, s[32:35], s48 offen
s_add_u32 s48, s48, 57344
buffer_load_dwordx4 v[132:135], v6, s[32:35], s48 offen
s_add_u32 s48, s48, 57344
buffer_load_dwordx4 v[136:139], v6, s[32:35], s48 offen
s_add_u32 s48, s48, 57344
buffer_load_dwordx4 v[140:143], v6, s[32:35], s48 offen
s_add_u32 s48, s48, 57344
buffer_load_dwordx4 v[144:147], v6, s[32:35], s48 offen
s_add_u32 s48, s48, 57344
buffer_load_dwordx4 v[148:151], v6, s[32:35], s48 offen
s_add_u32 s48, s48, 57344
buffer_load_dwordx4 v[152:155], v6, s[32:35], s48 offen
s_add_u32 s48, s48, 57344
buffer_load_dwordx4 v[156:159], v6, s[32:35], s48 offen
s_add_u32 s48, s48, 57344
buffer_load_dwordx4 v[160:163], v6, s[32:35], s48 offen
s_add_u32 s48, s48, 57344
buffer_load_dwordx4 v[164:167], v6, s[32:35], s48 offen
s_add_u32 s48, s48, 57344
buffer_load_dwordx4 v[168:171], v6, s[32:35], s48 offen
s_add_u32 s48, s48, 57344
buffer_load_dwordx4 v[172:175], v6, s[32:35], s48 offen
s_add_u32 s48, s48, 57344
buffer_load_dwordx4 v[176:179], v6, s[32:35], s48 offen
s_add_u32 s48, s48, 57344
buffer_load_dwordx4 v[180:183], v6, s[32:35], s48 offen
SP_noC1:
s_mul_i32 s45, s36, 14336
s_add_u32 m0, s45, 16384
s_add_u32 s46, s41, s45
buffer_load_dwordx4 v7, s[4:7], s46 offen offset:0 lds
buffer_load_dwordx4 v7, s[4:7], s46 offen offset:1024 lds
buffer_load_dwordx4 v7, s[4:7], s46 offen offset:2048 lds
buffer_load_dwordx4 v7, s[4:7], s46 offen offset:3072 lds
s_add_u32 m0, m0, 4096
s_add_u32 s46, s46, 4096
buffer_load_dwordx4 v7, s[4:7], s46 offen offset:0 lds
buffer_load_dwordx4 v7, s[4:7], s46 offen offset:1024 lds
buffer_load_dwordx4 v7, s[4:7], s46 offen offset:2048 lds
buffer_load_dwordx4 v7, s[4:7], s46 offen offset:3072 lds
s_add_u32 m0, m0, 4096
s_add_u32 s46, s46, 4096
buffer_load_dwordx4 v7, s[4:7], s46 offen offset:0 lds
buffer_load_dwordx4 v7, s[4:7], s46 offen offset:1024 lds
buffer_load_dwordx4 v7, s[4:7], s46 offen offset:2048 lds
buffer_load_dwordx4 v7, s[4:7], s46 offen offset:3072 lds
s_add_u32 m0, m0, 4096
s_add_u32 s46, s46, 4096
buffer_load_dwordx4 v7, s[4:7], s46 offen offset:0 lds
buffer_load_dwordx4 v7, s[4:7], s46 offen offset:1024 lds
s_cmp_ge_u32 s53, 14
s_cbranch_scc1 SP_noC1b
s_mov_b32 s90, 0x00003f80
s_mov_b32 s91, 0x3f800000
v_mov_b32 v200, 0
v_mov_b32 v201, 0
v_mov_b32 v202, 0
v_mov_b32 v203, 0
v_mov_b32 v204, 0
v_mov_b32 v205, 0
v_mov_b32 v206, 0
v_mov_b32 v207, 0
s_waitcnt vmcnt(21)
s_mov_b32 s45, 0
SP_Cloop:
s_set_gpr_idx_on s45, gpr_idx(SRC0)
v_dot2_f32_bf16 v200, v72, s90, v200
v_dot2_f32_bf16 v201, v72, s91, v201
v_dot2_f32_bf16 v202, v73, s90, v202
v_dot2_f32_bf16 v203, v73, s91, v203
v_dot2_f32_bf16 v204, v74, s90, v204
v_dot2_f32_bf16 v205, v74, s91, v205
v_dot2_f32_bf16 v206, v75, s90, v206
v_dot2_f32_bf16 v207, v75, s91, v207
v_dot2_f32_bf16 v200, v76, s90, v200
v_dot2_f32_bf16 v201, v76, s91, v201
v_dot2_f32_bf16 v202, v77, s90, v202
v_dot2_f32_bf16 v203, v77, s91, v203
v_dot2_f32_bf16 v204, v78, s90, v204
v_dot2_f32_bf16 v205, v78, s91, v205
v_dot2_f32_bf16 v206, v79, s90, v206
v_dot2_f32_bf16 v207, v79, s91, v207
v_dot2_f32_bf16 v200, v80, s90, v200
v_dot2_f32_bf16 v201, v80, s91, v201
v_dot2_f32_bf16 v202, v81, s90, v202
v_dot2_f32_bf16 v203, v81, s91, v203
v_dot2_f32_bf16 v204, v82, s90, v204
v_dot2_f32_bf16 v205, v82, s91, v205
v_dot2_f32_bf16 v206, v83, s90, v206
v_dot2_f32_bf16 v207, v83, s91, v207
v_dot2_f32_bf16 v200, v84, s90, v200
v_dot2_f32_bf16 v201, v84, s91, v201
v_dot2_f32_bf16 v202, v85, s90, v202
v_dot2_f32_bf16 v203, v85, s91, v203
v_dot2_f32_bf16 v204, v86, s90, v204
v_dot2_f32_bf16 v205, v86, s91, v205
v_dot2_f32_bf16 v206, v87, s90, v206
v_dot2_f32_bf16 v207, v87, s91, v207
v_dot2_f32_bf16 v200, v88, s90, v200
v_dot2_f32_bf16 v201, v88, s91, v201
v_dot2_f32_bf16 v202, v89, s90, v202
v_dot2_f32_bf16 v203, v89, s91, v203
v_dot2_f32_bf16 v204, v90, s90, v204
v_dot2_f32_bf16 v205, v90, s91, v205
v_dot2_f32_bf16 v206, v91, s90, v206
v_dot2_f32_bf16 v207, v91, s91, v207
v_dot2_f32_bf16 v200, v92, s90, v200
v_dot2_f32_bf16 v201, v92, s91, v201
v_dot2_f32_bf16 v202, v93, s90, v202
v_dot2_f32_bf16 v203, v93, s91, v203
v_dot2_f32_bf16 v204, v94, s90, v204
v_dot2_f32_bf16 v205, v94, s91, v205
v_dot2_f32_bf16 v206, v95, s90, v206
v_dot2_f32_bf16 v207, v95, s91, v207
v_dot2_f32_bf16 v200, v96, s90, v200
v_dot2_f32_bf16 v201, v96, s91, v201
v_dot2_f32_bf16 v202, v97, s90, v202
v_dot2_f32_bf16 v203, v97, s91, v203
v_dot2_f32_bf16 v204, v98, s90, v204
v_dot2_f32_bf16 v205, v98, s91, v205
v_dot2_f32_bf16 v206, v99, s90, v206
v_dot2_f32_bf16 v207, v99, s91, v207
s_set_gpr_idx_off
    s_add_u32 s45, s45, 28
    s_waitcnt vmcnt(14)
    s_cmp_lt_u32 s45, 112
    s_cbranch_scc1 SP_Cloop
    s_lshl_b32 s45, s36, 2
    v_add_u32 v13, s45, v4
    v_lshlrev_b32 v13, 9, v13
    v_lshl_add_u32 v13, v3, 5, v13
    s_nop 2
    ds_write_b128 v13, v[200:203]
    ds_write_b128 v13, v[204:207] offset:16
    SP_noC1b:

    s_mul_i32 s45, s36, 14336
    s_add_u32 s45, s45, 16384
    v_mul_u32_u24 v5, 896, v3
    v_lshl_add_u32 v5, v4, 4, v5
    v_add_u32 v5, s45, v5
    s_waitcnt vmcnt(0)

ds_read_b128 v[16:19], v5 offset:0
ds_read_b128 v[20:23], v5 offset:64
ds_read_b128 v[24:27], v5 offset:128
ds_read_b128 v[28:31], v5 offset:192
ds_read_b128 v[32:35], v5 offset:256
ds_read_b128 v[36:39], v5 offset:320
ds_read_b128 v[40:43], v5 offset:384
ds_read_b128 v[44:47], v5 offset:448
ds_read_b128 v[48:51], v5 offset:512
ds_read_b128 v[52:55], v5 offset:576
ds_read_b128 v[56:59], v5 offset:640
ds_read_b128 v[60:63], v5 offset:704
ds_read_b128 v[64:67], v5 offset:768
ds_read_b128 v[68:71], v5 offset:832
v_mov_b32 v8, 0x3f803f80
v_mov_b32 v9, 0x3f803f80
v_mov_b32 v10, 0x3f803f80
v_mov_b32 v11, 0x3f803f80
s_waitcnt lgkmcnt(0)
s_barrier
v_mfma_f32_16x16x32_bf16 v[184:187], v[16:19], v[8:11], 0
v_mfma_f32_16x16x32_bf16 v[188:191], v[16:19], v[16:19], 0
v_mfma_f32_16x16x32_bf16 v[184:187], v[20:23], v[8:11], v[184:187]
v_mfma_f32_16x16x32_bf16 v[188:191], v[20:23], v[20:23], v[188:191]
v_mfma_f32_16x16x32_bf16 v[184:187], v[24:27], v[8:11], v[184:187]
v_mfma_f32_16x16x32_bf16 v[188:191], v[24:27], v[24:27], v[188:191]
v_mfma_f32_16x16x32_bf16 v[184:187], v[28:31], v[8:11], v[184:187]
v_mfma_f32_16x16x32_bf16 v[188:191], v[28:31], v[28:31], v[188:191]
v_mfma_f32_16x16x32_bf16 v[184:187], v[32:35], v[8:11], v[184:187]
v_mfma_f32_16x16x32_bf16 v[188:191], v[32:35], v[32:35], v[188:191]
v_mfma_f32_16x16x32_bf16 v[184:187], v[36:39], v[8:11], v[184:187]
v_mfma_f32_16x16x32_bf16 v[188:191], v[36:39], v[36:39], v[188:191]
v_mfma_f32_16x16x32_bf16 v[184:187], v[40:43], v[8:11], v[184:187]
v_mfma_f32_16x16x32_bf16 v[188:191], v[40:43], v[40:43], v[188:191]
v_mfma_f32_16x16x32_bf16 v[184:187], v[44:47], v[8:11], v[184:187]
v_mfma_f32_16x16x32_bf16 v[188:191], v[44:47], v[44:47], v[188:191]
v_mfma_f32_16x16x32_bf16 v[184:187], v[48:51], v[8:11], v[184:187]
v_mfma_f32_16x16x32_bf16 v[188:191], v[48:51], v[48:51], v[188:191]
v_mfma_f32_16x16x32_bf16 v[184:187], v[52:55], v[8:11], v[184:187]
v_mfma_f32_16x16x32_bf16 v[188:191], v[52:55], v[52:55], v[188:191]
v_mfma_f32_16x16x32_bf16 v[184:187], v[56:59], v[8:11], v[184:187]
v_mfma_f32_16x16x32_bf16 v[188:191], v[56:59], v[56:59], v[188:191]
v_mfma_f32_16x16x32_bf16 v[184:187], v[60:63], v[8:11], v[184:187]
v_mfma_f32_16x16x32_bf16 v[188:191], v[60:63], v[60:63], v[188:191]
v_mfma_f32_16x16x32_bf16 v[184:187], v[64:67], v[8:11], v[184:187]
v_mfma_f32_16x16x32_bf16 v[188:191], v[64:67], v[64:67], v[188:191]
v_mfma_f32_16x16x32_bf16 v[184:187], v[68:71], v[8:11], v[184:187]
v_mfma_f32_16x16x32_bf16 v[188:191], v[68:71], v[68:71], v[188:191]
    v_and_b32 v12, 3, v1
    v_cmp_eq_u32 s[90:91], 1, v12
    v_cmp_eq_u32 s[92:93], 2, v12
    v_cmp_eq_u32 s[94:95], 3, v12
    v_lshrrev_b32 v13, 2, v3
    v_cmp_eq_u32 s[96:97], v13, v4
    s_nop 7
    v_cndmask_b32 v184, v184, v185, s[90:91]
    v_cndmask_b32 v188, v188, v189, s[90:91]
    v_cndmask_b32 v184, v184, v186, s[92:93]
    v_cndmask_b32 v188, v188, v190, s[92:93]
    v_cndmask_b32 v184, v184, v187, s[94:95]
    v_cndmask_b32 v188, v188, v191, s[94:95]
    v_mul_f32 v184, 0x3b124925, v184
    v_mul_f32 v188, 0x3b124925, v188
    v_fma_f32 v188, -v184, v184, v188
    v_max_f32 v188, 0, v188

v_cvt_pk_bf16_f32 v184, v184, v184
v_lshlrev_b32 v184, 16, v184
v_cvt_pk_bf16_f32 v188, v188, v188
v_lshlrev_b32 v188, 16, v188
v_add_f32 v188, 0x3727c5ac, v188
v_cvt_pk_bf16_f32 v188, v188, v188
v_lshlrev_b32 v188, 16, v188
v_sqrt_f32 v188, v188
s_nop 0
v_cvt_pk_bf16_f32 v188, v188, v188
v_lshlrev_b32 v188, 16, v188
    v_mov_b32 v185, v188
    s_lshl_b32 s45, s52, 9
    s_lshl_b32 s46, s36, 7
    s_add_u32 s45, s45, s46
    s_add_u32 s45, s45, 262144
    v_lshlrev_b32 v13, 3, v3
    s_mov_b64 exec, s[96:97]
    buffer_store_dwordx2 v[184:185], v13, s[16:19], s45 offen sc1
    s_mov_b64 exec, -1

s_cmp_ge_u32 s53, 14
    s_cbranch_scc1 SP_noC2
    s_cmp_ge_u32 s36, 2
    s_cbranch_scc1 SP_noC2
    v_lshlrev_b32 v13, 2, v0
    v_mov_b32 v14, v13

ds_read_b32 v72, v14 offset:0
ds_read_b32 v73, v14 offset:512
ds_read_b32 v74, v14 offset:1024
ds_read_b32 v75, v14 offset:1536
ds_read_b32 v76, v14 offset:2048
ds_read_b32 v77, v14 offset:2560
ds_read_b32 v78, v14 offset:3072
ds_read_b32 v79, v14 offset:3584
ds_read_b32 v80, v14 offset:4096
ds_read_b32 v81, v14 offset:4608
ds_read_b32 v82, v14 offset:5120
ds_read_b32 v83, v14 offset:5632
ds_read_b32 v84, v14 offset:6144
ds_read_b32 v85, v14 offset:6656
ds_read_b32 v86, v14 offset:7168
ds_read_b32 v87, v14 offset:7680
s_waitcnt lgkmcnt(0)
v_add_f32 v72, v72, v80
v_add_f32 v73, v73, v81
v_add_f32 v74, v74, v82
v_add_f32 v75, v75, v83
v_add_f32 v76, v76, v84
v_add_f32 v77, v77, v85
v_add_f32 v78, v78, v86
v_add_f32 v79, v79, v87
v_add_f32 v72, v72, v76
v_add_f32 v73, v73, v77
v_add_f32 v74, v74, v78
v_add_f32 v75, v75, v79
v_add_f32 v72, v72, v74
v_add_f32 v73, v73, v75
v_add_f32 v72, v72, v73
    s_cmp_ge_u32 s53, 7
    s_cselect_b32 s45, 7168, 0
    s_lshl_b32 s46, s38, 9
    s_add_u32 s45, s45, s46
    s_add_u32 s45, s45, 278528
    buffer_store_dword v72, v13, s[16:19], s45 offen sc1
    SP_noC2:

s_waitcnt vmcnt(0) lgkmcnt(0)
s_mul_i32 s50, s50, 0x9E3779B1
s_add_u32 s50, s50, 0x7F4A7C15
s_barrier
s_lshl_b32 s45, s37, 6
s_add_u32 s45, s45, 4096
s_cmp_lg_u32 s36, 0
    s_cbranch_scc1 SP_nf1
    v_mov_b32 v14, 0
    v_mov_b32 v15, s50
    s_mov_b64 exec, 1
    buffer_store_dword v15, v14, s[16:19], s45 offen sc1
    s_mov_b64 exec, -1
    SP_nf1:
s_cmp_lg_u32 s2, 224
    s_cbranch_scc1 G_noep
    s_cmp_lg_u32 s36, 0
    s_cbranch_scc1 G_noep
    v_and_b32 v2, 63, v0
    s_mov_b32 s51, 0x8000
v_add_u32 v4, 0, v2
        v_min_u32 v4, 223, v4
        v_lshlrev_b32 v4, 8, v4
        v_add_u32 v4, 196608, v4
v_add_u32 v5, 64, v2
        v_min_u32 v5, 223, v5
        v_lshlrev_b32 v5, 8, v5
        v_add_u32 v5, 196608, v5
v_add_u32 v6, 128, v2
        v_min_u32 v6, 223, v6
        v_lshlrev_b32 v6, 8, v6
        v_add_u32 v6, 196608, v6
v_add_u32 v7, 192, v2
        v_min_u32 v7, 223, v7
        v_lshlrev_b32 v7, 8, v7
        v_add_u32 v7, 196608, v7
v_min_u32 v8, 31, v2
    v_lshlrev_b32 v8, 6, v8
    v_add_u32 v8, 4096, v8
    G_ep_loop:
buffer_load_dword v10, v4, s[16:19], 0 offen sc1
buffer_load_dword v11, v5, s[16:19], 0 offen sc1
buffer_load_dword v12, v6, s[16:19], 0 offen sc1
buffer_load_dword v13, v7, s[16:19], 0 offen sc1
buffer_load_dword v14, v8, s[16:19], 0 offen sc1
s_waitcnt vmcnt(0)
v_xor_b32 v10, s50, v10
v_xor_b32 v11, s50, v11
v_xor_b32 v12, s50, v12
v_xor_b32 v13, s50, v13
v_xor_b32 v14, s50, v14
v_or3_b32 v10, v10, v11, v12
v_or3_b32 v10, v10, v13, v14
v_cmp_ne_u32 vcc, 0, v10
s_cbranch_vccz G_ep_done
    s_sleep 8
    s_sub_u32 s51, s51, 1
    s_cmp_lg_u32 s51, 0
    s_cbranch_scc1 G_ep_loop
    G_ep_done:
    v_mov_b32 v2, 0
    v_mov_b32 v3, s50
    s_mov_b64 exec, 1
    buffer_store_dword v3, v2, s[16:19], 0 offen sc1
    s_mov_b64 exec, -1
    s_waitcnt vmcnt(0)
    G_noep:
L_end:
s_endpgm
.section .rodata,"a"
.p2align 6
.amdhsa_kernel recurrent_scan__ssm_conv_h3__geglu_ffn__prompt_kernel
  .amdhsa_next_free_vgpr 512
  .amdhsa_next_free_sgpr 102
  .amdhsa_accum_offset 256
  .amdhsa_group_segment_fixed_size 0
  .amdhsa_kernarg_size 104
  .amdhsa_user_sgpr_count 2
  .amdhsa_user_sgpr_kernarg_segment_ptr 1
  .amdhsa_system_sgpr_workgroup_id_x 1
.end_amdhsa_kernel
.text
```
